```python
import torch

def _softmax(x, axis=-1):
    return torch.softmax(x, dim=axis)
def _gelu(x):
    return torch.nn.functional.gelu(x, approximate="tanh")
def _silu(x):
    return torch.nn.functional.silu(x)
def _sigmoid(x):
    return torch.sigmoid(x)
def _layernorm(x, axis=-1, eps=1e-5):
    m = x.mean(dim=axis, keepdim=True)
    v = x.var(dim=axis, keepdim=True, unbiased=False)
    return (x - m) / torch.sqrt(v + eps)
def _scatter_add(tgt, idx, src, axis=0):
    return tgt.clone().index_add_(axis, idx, src)
def _segment_sum(src, seg, n):
    out = torch.zeros((n,) + src.shape[1:], dtype=src.dtype)
    return out.index_add_(0, seg, src)
def _pad(x, pw):
    flat = tuple(v for pair in reversed(pw) for v in pair)
    return torch.nn.functional.pad(x, flat)

kernel_name = 'gated_mix__ssm_conv_s5__mixer_channel_mlp__prompt'

def setup_inputs():

    _w = (lambda a: (lambda t: t.to(torch.bfloat16) if t.is_floating_point() else t)(torch.as_tensor(a)))
    def _A_setup():
        B, S, D = 1, 2048, 448
        P = D
        Lambda_re = -0.5 * (lambda _x: torch.exp(torch.as_tensor(_x)))((lambda *s: torch.randn(*s, dtype=torch.bfloat16) * 0.4)(P))
        Lambda_im = (lambda *s: torch.randn(*s, dtype=torch.bfloat16) * 0.8)(P) * 1.0
        B_re = (lambda *s: torch.randn(*s, dtype=torch.bfloat16) * 0.8)(P, D) * (D ** -0.5)
        B_im = (lambda *s: torch.randn(*s, dtype=torch.bfloat16) * 0.8)(P, D) * (D ** -0.5)
        C_re = (lambda *s: torch.randn(*s, dtype=torch.bfloat16) * 0.8)(D, P) * (P ** -0.5)
        C_im = (lambda *s: torch.randn(*s, dtype=torch.bfloat16) * 0.8)(D, P) * (P ** -0.5)
        log_dt = (lambda *s: torch.randn(*s, dtype=torch.bfloat16) * 0.4)(P) * 0.3 - 2.0
        Dskip = (lambda *s: torch.randn(*s, dtype=torch.bfloat16) * 0.1)(D)
        return {
            "x": _w((lambda *s: torch.randn(*s, dtype=torch.bfloat16) * 0.05)(B, S, D)),
            "Lambda_re": _w(Lambda_re),
            "Lambda_im": _w(Lambda_im),
            "B_re": _w(B_re),
            "B_im": _w(B_im),
            "C_re": _w(C_re),
            "C_im": _w(C_im),
            "log_dt": _w(log_dt),
            "Dskip": _w(Dskip),
        }
    _A_in = _A_setup()

    def _B_setup():
        B, S, D, F = 1, 2048, 448, 1792
        return {
            "x": _w((lambda *s: torch.randn(*s, dtype=torch.bfloat16) * 0.05)(B, S, D)),
            "w1": _w((lambda *s: torch.randn(*s, dtype=torch.bfloat16) * 0.8)(D, F) * (D ** -0.5)),
            "b1": _w((lambda *s: torch.randn(*s, dtype=torch.bfloat16) * 0.4)(F)),
            "w2": _w((lambda *s: torch.randn(*s, dtype=torch.bfloat16) * 0.05)(F, D) * (F ** -0.5)),
            "b2": _w((lambda *s: torch.randn(*s, dtype=torch.bfloat16) * 0.05)(D)),
        }
    _B_in = _B_setup()

    return {
        "A_x": _A_in["x"],
        "A_Lambda_re": _A_in["Lambda_re"],
        "A_Lambda_im": _A_in["Lambda_im"],
        "A_B_re": _A_in["B_re"],
        "A_B_im": _A_in["B_im"],
        "A_C_re": _A_in["C_re"],
        "A_C_im": _A_in["C_im"],
        "A_log_dt": _A_in["log_dt"],
        "A_Dskip": _A_in["Dskip"],
        "B_x": _B_in["x"],
        "B_w1": _B_in["w1"],
        "B_b1": _B_in["b1"],
        "B_w2": _B_in["w2"],
        "B_b2": _B_in["b2"],
        "gate_w": _w((lambda *s: torch.randn(*s, dtype=torch.bfloat16) * 0.05)(448) * 16.0),
    }

def reference(A_x, A_Lambda_re, A_Lambda_im, A_B_re, A_B_im, A_C_re, A_C_im, A_log_dt, A_Dskip, B_x, B_w1, B_b1, B_w2, B_b2, gate_w):
    def _A_ref(x, Lambda_re, Lambda_im, B_re, B_im, C_re, C_im, log_dt, Dskip):
        Bsz, L, H = x.shape
        Lam = Lambda_re + 1j * Lambda_im
        Bmat = B_re + 1j * B_im
        Cmat = C_re + 1j * C_im
        dt = torch.exp(log_dt)
        Lam_bar = torch.exp(dt * Lam)
        B_bar = ((Lam_bar - 1.0) / Lam)[:, None] * Bmat
        Bu = torch.einsum("bld,pd->blp", x + 0j, B_bar)
        h = torch.zeros_like(Bu[:, 0, :])
        hs = []
        for t in range(L):
            h = Lam_bar[None, :] * h + Bu[:, t, :]
            hs.append(h)
        hseq = torch.stack(hs, 1)
        y = 2.0 * torch.einsum("blp,dp->bld", hseq, Cmat).real + x * Dskip[None, None, :]
        return y

    def _B_ref(x, w1, b1, w2, b2):
        y = _layernorm(x, axis=-1)
        h = _gelu(torch.einsum("bsd,df->bsf", y, w1) + b1)
        return torch.einsum("bsf,fd->bsd", h, w2) + b2

    x = A_x
    g = _sigmoid((x * gate_w).sum(-1, keepdims=True))
    a = _A_ref(x, A_Lambda_re, A_Lambda_im, A_B_re, A_B_im, A_C_re, A_C_im, A_log_dt, A_Dskip)
    b = _B_ref(x, B_w1, B_b1, B_w2, B_b2)
    return g * a + (1 - g) * b
```

```asm
; @launch grid=(256,1,1) block=(512,1,1) lds=163840
.amdgcn_target "amdgcn-amd-amdhsa--gfx950"
.text
.globl gated_mix__ssm_conv_s5__mixer_channel_mlp__prompt_kernel
.p2align 8
.type gated_mix__ssm_conv_s5__mixer_channel_mlp__prompt_kernel,@function
gated_mix__ssm_conv_s5__mixer_channel_mlp__prompt_kernel:
s_cmp_ge_u32 s2, 256
s_cbranch_scc1 Lend
s_load_dwordx2 s[4:5], s[0:1], 0
s_load_dwordx2 s[8:9], s[0:1], 24
s_load_dwordx2 s[12:13], s[0:1], 32
s_load_dwordx2 s[32:33], s[0:1], 136
s_load_dwordx4 s[36:39], s[0:1], 8
s_load_dwordx4 s[40:43], s[0:1], 56
s_load_dwordx2 s[16:17], s[0:1], 80
s_load_dwordx2 s[20:21], s[0:1], 96
s_load_dwordx2 s[24:25], s[0:1], 40
s_load_dwordx2 s[28:29], s[0:1], 48
s_load_dwordx2 s[76:77], s[0:1], 120
s_load_dwordx2 s[44:45], s[0:1], 88
s_load_dwordx2 s[46:47], s[0:1], 104
s_load_dwordx2 s[72:73], s[0:1], 112
v_lshrrev_b32 v144, 6, v0
v_and_b32 v0, 63, v0
v_readfirstlane_b32 s84, v144
s_and_b32 s91, s2, 1
s_lshl_b32 s91, s91, 2
s_bfe_u32 s92, s2, 0x20001
s_lshr_b32 s94, s2, 3
s_mov_b32 s6, 1835008
s_mov_b32 s7, 0x20000
s_and_b32 s85, s84, 3
s_lshr_b32 s86, s84, 2
s_cmp_ge_u32 s94, 4
s_cbranch_scc1 MAIN
s_lshl_b32 s87, s92, 3
s_add_u32 s87, s87, s91
s_add_u32 s87, s87, s94
s_cmp_lt_u32 s84, 4
s_cbranch_scc1 HELPX0
s_branch HELPW
HELPX0:
v_and_b32 v140, 15, v0
v_and_b32 v141, 48, v0
v_lshl_add_u32 v140, s85, 4, v140
s_movk_i32 s94, 896
v_mad_u32_u24 v145, v140, s94, v141
v_lshlrev_b32 v142, 4, v0
s_mul_i32 s3, s87, 57344
s_lshl_b32 s94, s85, 11
s_add_u32 m0, s94, 4096
s_mov_b32 s74, 896
s_mov_b32 s75, 0x20000
s_waitcnt lgkmcnt(0)
buffer_load_dwordx4 v142, s[72:75], 0 offen lds
buffer_load_dwordx4 v[16:19], v145, s[4:7], s3 offen offset:0
buffer_load_dwordx4 v[20:23], v145, s[4:7], s3 offen offset:64
buffer_load_dwordx4 v[24:27], v145, s[4:7], s3 offen offset:128
buffer_load_dwordx4 v[28:31], v145, s[4:7], s3 offen offset:192
buffer_load_dwordx4 v[32:35], v145, s[4:7], s3 offen offset:256
buffer_load_dwordx4 v[36:39], v145, s[4:7], s3 offen offset:320
buffer_load_dwordx4 v[40:43], v145, s[4:7], s3 offen offset:384
buffer_load_dwordx4 v[44:47], v145, s[4:7], s3 offen offset:448
buffer_load_dwordx4 v[48:51], v145, s[4:7], s3 offen offset:512
buffer_load_dwordx4 v[52:55], v145, s[4:7], s3 offen offset:576
buffer_load_dwordx4 v[56:59], v145, s[4:7], s3 offen offset:640
buffer_load_dwordx4 v[60:63], v145, s[4:7], s3 offen offset:704
buffer_load_dwordx4 v[64:67], v145, s[4:7], s3 offen offset:768
buffer_load_dwordx4 v[68:71], v145, s[4:7], s3 offen offset:832
s_branch HELPX
MAIN:
s_sub_u32 s94, s94, 4
s_lshl_b32 s92, s92, 3
s_sub_u32 s95, 16, s91
s_sub_u32 s95, s94, s95
s_cselect_b32 s94, s94, s95
s_cselect_b32 s87, 0, 4
s_cmp_eq_u32 s87, s91
s_cselect_b32 s95, 8, 11
s_cselect_b32 s88, 4, 3
s_mul_i32 s95, s94, s95
s_add_u32 s87, s87, s92
s_lshr_b32 s95, s95, 5
s_mul_i32 s88, s88, s95
s_add_u32 s87, s87, s95
s_sub_u32 s94, s94, s88
s_add_u32 s88, s94, s91
s_cmp_eq_u32 s94, 3
s_cselect_b32 s88, 3, s88
v_lshrrev_b32 v144, 3, v0
v_lshrrev_b32 v145, 4, v0
v_and_b32 v146, 7, v0
v_lshrrev_b32 v147, 5, v0
v_and_b32 v148, 3, v144
v_xor_b32 v149, v146, v145
v_lshlrev_b32 v149, 4, v149
s_and_b32 s94, s85, 1
s_lshl_b32 s94, s94, 6
s_movk_i32 s95, 896
v_lshl_add_u32 v150, v147, 4, v148
v_xor_b32 v192, s94, v149
v_mad_u32_u24 v192, v150, s95, v192
s_lshl_b32 s91, s87, 1
s_add_u32 s91, s91, s86
s_lshl_b32 s91, s91, 3
s_add_u32 s91, s91, s85
s_mul_i32 s3, s91, 3584
s_mul_i32 s70, s84, 7168
s_add_u32 s70, s70, 106496
s_lshl_b32 s90, s85, 12
s_add_u32 s90, s90, 8192
v_mad_u32_u24 v7, v144, s95, v149
v_xor_b32 v8, 64, v7
s_lshl_b32 s91, s88, 2
s_add_u32 s91, s91, s85
s_mul_i32 s63, s91, 14336
s_mul_i32 s91, s86, 7168
s_add_u32 s91, s91, s63
s_lshl_b32 s92, s86, 11
s_add_u32 s92, s92, s90
s_mov_b32 s10, 401408
s_mov_b32 s11, 0x20000
s_mov_b32 s14, 402432
s_mov_b32 s15, 0x20000
s_add_u32 m0, s70, 0
s_waitcnt lgkmcnt(0)
buffer_load_dwordx4 v192, s[4:7], s3 offen lds
s_sub_u32 s12, s12, 1024
s_subb_u32 s13, s13, 0
s_add_u32 m0, s92, 0
s_nop 0
buffer_load_dwordx4 v7, s[8:11], s91 offen lds
buffer_load_dwordx4 v8, s[12:15], s91 offen offset:1024 lds
s_load_dword s89, s[32:33], 0
v_and_b32 v180, 7, v0
v_bfe_u32 v181, v0, 4, 1
v_lshl_add_u32 v180, v181, 3, v180
v_lshl_add_u32 v180, s85, 4, v180
v_lshl_add_u32 v180, s88, 6, v180
v_lshlrev_b32 v180, 1, v180
global_load_ushort v178, v180, s[40:41]
global_load_ushort v176, v180, s[36:37]
s_add_u32 m0, s70, 896
s_nop 0
buffer_load_dwordx4 v192, s[4:7], s3 offen offset:128 lds
global_load_ushort v177, v180, s[38:39]
s_mov_b64 exec, 0
s_cmp_eq_u32 s84, 0
s_cbranch_scc1 PADS0
s_cmp_eq_u32 s84, 1
s_cbranch_scc1 PADS1
s_cmp_eq_u32 s84, 2
s_cbranch_scc1 PADL1
s_cmp_eq_u32 s84, 3
s_cbranch_scc1 PADL2
s_cmp_eq_u32 s84, 4
s_cbranch_scc1 PADL0
s_cmp_eq_u32 s84, 5
s_cbranch_scc1 PADS2
HOPB:
s_mov_b64 exec, -1
v_and_b32 v150, 31, v0
v_bfe_u32 v151, v0, 1, 3
v_xor_b32 v151, v147, v151
v_lshlrev_b32 v151, 4, v151
v_lshl_add_u32 v152, s86, 2, v148
s_movk_i32 s94, 7168
v_mad_u32_u24 v208, v152, s94, v151
v_lshl_add_u32 v248, v150, 7, v151
s_add_u32 m0, s92, 16384
s_add_u32 s91, s91, 128
buffer_load_dwordx4 v7, s[8:11], s91 offen lds
v_lshl_add_u32 v208, v146, 7, v208
v_add_u32 v248, s90, v248
v_add_u32 v208, 106496, v208
v_xor_b32 v249, 32, v248
v_xor_b32 v209, 32, v208
v_xor_b32 v250, 64, v248
v_xor_b32 v210, 64, v208
v_xor_b32 v251, 0x60, v248
v_xor_b32 v211, 0x60, v208
buffer_load_dwordx4 v8, s[12:15], s91 offen offset:1024 lds
v_add_u32 v252, 0x10000, v248
v_add_u32 v253, 0x10000, v249
v_add_u32 v254, 0x10000, v250
v_add_u32 v255, 0x10000, v251
v_bfe_u32 v152, v0, 2, 2
v_and_b32 v154, 1, v145
v_lshl_add_u32 v153, v147, 2, v152
v_and_b32 v155, 3, v0
v_lshlrev_b32 v1, 7, v153
s_add_u32 m0, s70, 1792
s_nop 0
buffer_load_dwordx4 v192, s[4:7], s3 offen offset:256 lds
v_lshrrev_b32 v156, 1, v152
s_and_b32 s94, s85, 1
v_xor_b32 v156, s94, v156
v_lshrrev_b32 v157, 1, v153
v_bfe_u32 v158, v0, 1, 1
v_lshl_add_u32 v158, v154, 1, v158
s_lshl_b32 s94, s94, 2
v_xor_b32 v157, v157, v158
v_and_b32 v158, 1, v0
s_add_u32 m0, s92, 32768
s_add_u32 s91, s91, 128
buffer_load_dwordx4 v7, s[8:11], s91 offen lds
v_xor_b32 v157, s94, v157
v_lshl_add_u32 v195, v158, 3, v1
s_and_b32 s94, s84, 6
s_mul_i32 s94, s94, 7168
s_lshl_b32 s95, s88, 10
s_add_u32 s94, s94, s95
s_add_u32 s94, s94, 106496
v_lshl_add_u32 v195, v157, 4, v195
v_lshl_add_u32 v1, v156, 6, v1
buffer_load_dwordx4 v8, s[12:15], s91 offen offset:1024 lds
v_add_u32 v195, s94, v195
v_lshl_add_u32 v1, v154, 5, v1
v_xor_b32 v196, 64, v195
s_mov_b32 s34, 268435456
s_mov_b32 s35, 0x20000
s_mov_b32 s96, 0
s_mov_b32 s97, -1
s_lshl_b32 s71, s88, 2
s_add_u32 s71, s71, s85
s_add_u32 m0, s70, 2688
s_nop 0
buffer_load_dwordx4 v192, s[4:7], s3 offen offset:384 lds
s_lshl_b32 s71, s71, 4
s_lshr_b32 s72, s87, 1
s_add_u32 s71, s71, s72
s_sub_u32 s71, s71, s85
s_lshl_b32 s71, s71, 6
s_and_b32 s72, s87, 1
s_add_u32 s71, s71, s72
s_lshl_b32 s71, s71, 3
s_mul_i32 s72, s72, 248
s_add_u32 m0, s92, 49152
s_add_u32 s91, s91, 128
buffer_load_dwordx4 v7, s[8:11], s91 offen lds
s_lshl_b32 s73, s85, 8
s_add_u32 s72, s72, s73
s_add_u32 s72, s72, s71
s_add_u32 s72, s72, 131072
s_add_u32 s73, s71, 393216
s_lshl_b32 s71, s88, 12
s_add_u32 s74, s71, 32768
s_lshl_b32 s71, s87, 10
s_add_u32 s75, s71, 65536
buffer_load_dwordx4 v8, s[12:15], s91 offen offset:1024 lds
s_add_u32 s36, s75, 32768
s_add_u32 m0, s70, 3584
s_nop 0
buffer_load_dwordx4 v192, s[4:7], s3 offen offset:512 lds
s_add_u32 m0, s70, 4480
s_nop 0
buffer_load_dwordx4 v192, s[4:7], s3 offen offset:640 lds
s_add_u32 m0, s70, 5376
s_nop 0
buffer_load_dwordx4 v192, s[4:7], s3 offen offset:768 lds
s_cmp_ge_u32 s84, 4
s_cbranch_scc1 PS1
v_and_b32 v6, 1, v145
v_lshl_add_u32 v159, v147, 3, v148
v_lshlrev_b32 v6, 2, v6
s_movk_i32 s71, 3584
v_xor_b32 v6, v146, v6
v_lshlrev_b32 v6, 4, v6
v_mad_u32_u24 v5, v159, s71, v6
v_add_u32 v6, 13312, v5
s_sub_u32 s16, s16, 2048
s_subb_u32 s17, s17, 0
s_mov_b32 s18, 1607680
s_mov_b32 s19, 0x20000
s_mul_i32 s62, s85, 57344
s_lshl_b32 s71, s88, 9
s_add_u32 s62, s62, s71
s_add_u32 s62, s62, 2048
s_sub_u32 s20, s20, 2048
s_subb_u32 s21, s21, 0
s_mov_b32 s22, 1607680
s_mov_b32 s23, 0x20000
s_mov_b64 s[26:27], s[10:11]
s_mov_b64 s[30:31], s[10:11]
s_mov_b64 s[82:83], s[10:11]
s_branch ROLEL
PS1:
s_branch ROLES
.p2align 12
PADL0:
s_cbranch_execz HOPB
ROLEL:
s_waitcnt vmcnt(15)
s_waitcnt lgkmcnt(0)
s_or_b32 s89, s89, 1
s_add_u32 s89, s89, 1013904242
s_barrier
s_add_u32 m0, s90, 65536
s_add_u32 s91, s63, 512
s_add_u32 s92, s63, 5632
ds_read_b128 v[128:131], v248 offset:0
buffer_load_dwordx4 v7, s[8:11], s91 offen offset:0 lds
ds_read_b128 v[16:19], v208 offset:0
v_bfe_u32 v179, v0, 3, 1
v_lshl_add_u32 v1, v155, 3, v1
s_mov_b32 s44, 3237186
s_waitcnt vmcnt(15)
v_lshlrev_b32 v178, 16, v178
s_lshr_b32 s94, s85, 1
ds_read_b128 v[132:135], v249 offset:0
buffer_load_dwordx4 v8, s[12:15], s91 offen offset:1024 lds
ds_read_b128 v[20:23], v209 offset:0
s_waitcnt vmcnt(15)
v_lshlrev_b32 v176, 16, v176
s_lshl_b32 s94, s94, 11
s_mov_b32 s98, 2184246
s_waitcnt vmcnt(13)
v_lshlrev_b32 v177, 16, v177
s_add_u32 s94, s94, 8192
v_add_u32 v1, s94, v1
ds_read_b128 v[136:139], v250 offset:0
buffer_load_dwordx4 v7, s[8:11], s92 offen offset:2048 lds
ds_read_b128 v[24:27], v210 offset:0
v_mul_f32 v178, 0x3fb8aa3b, v178
s_lshl_b32 s94, s86, 13
v_lshlrev_b32 v179, 31, v179
s_add_u32 s94, s94, 106496
ds_read_b128 v[140:143], v251 offset:0
buffer_load_dwordx4 v8, s[12:15], s92 offen offset:3072 lds
ds_read_b128 v[28:31], v211 offset:0
v_exp_f32 v178, v178
v_add_u32 v2, 0x10000, v1
s_cmp_eq_u32 s88, 1
s_cselect_b32 s44, 152630, s44
s_cselect_b32 s98, 156995, s98
v_lshl_add_u32 v3, v0, 4, s94
s_waitcnt vmcnt(13)
s_barrier
s_waitcnt lgkmcnt(6)
v_mfma_f32_32x32x16_bf16 v[160:175], v[16:19], v[128:131], 0
s_add_u32 m0, s90, 81920
s_add_u32 s91, s63, 640
s_add_u32 s92, s63, 5760
ds_read_b128 v[128:131], v248 offset:16384
buffer_load_dwordx4 v7, s[8:11], s91 offen offset:0 lds
ds_read_b128 v[32:35], v208 offset:1024
v_mul_f32 v182, v176, v176
v_lshlrev_b32 v247, 3, v150
s_getreg_b32 s45, hwreg(HW_REG_XCC_ID, 0, 4)
s_andn2_b32 s71, s89, 15
s_or_b32 s45, s45, s71
v_fmac_f32 v182, v177, v177
s_waitcnt lgkmcnt(6)
v_mfma_f32_32x32x16_bf16 v[160:175], v[20:23], v[132:135], v[160:175]
ds_read_b128 v[132:135], v249 offset:16384
buffer_load_dwordx4 v8, s[12:15], s91 offen offset:1024 lds
ds_read_b128 v[36:39], v209 offset:1024
v_cvt_pk_bf16_f32 v178, v178, v178
v_lshl_add_u32 v4, s85, 10, v3
s_waitcnt lgkmcnt(6)
v_mfma_f32_32x32x16_bf16 v[160:175], v[24:27], v[136:139], v[160:175]
ds_read_b128 v[136:139], v250 offset:16384
buffer_load_dwordx4 v7, s[8:11], s92 offen offset:2048 lds
ds_read_b128 v[40:43], v210 offset:1024
v_rcp_f32 v182, v182
v_lshl_add_u32 v247, s85, 8, v247
v_lshlrev_b32 v178, 16, v178
s_waitcnt lgkmcnt(6)
v_mfma_f32_32x32x16_bf16 v[160:175], v[28:31], v[140:143], v[160:175]
ds_read_b128 v[140:143], v251 offset:16384
buffer_load_dwordx4 v8, s[12:15], s92 offen offset:3072 lds
ds_read_b128 v[44:47], v211 offset:1024
v_mul_f32 v180, v178, v176
v_bfe_u32 v156, v0, 2, 1
s_cmp_eq_u32 s88, 2
s_cselect_b32 s44, 1261669, s44
s_cselect_b32 s98, 1062484, s98
v_mul_f32 v181, v178, v177
s_waitcnt vmcnt(14)
s_barrier
s_waitcnt lgkmcnt(6)
v_mfma_f32_32x32x16_bf16 v[160:175], v[32:35], v[128:131], v[160:175]
s_add_u32 m0, s90, 0
s_add_u32 s91, s63, 768
s_add_u32 s92, s63, 5888
ds_read_b128 v[128:131], v248 offset:32768
buffer_load_dwordx4 v7, s[8:11], s91 offen offset:0 lds
ds_read_b128 v[48:51], v208 offset:2048
v_mul_f32 v180, 0x3fb8aa3b, v180
v_lshlrev_b32 v194, 1, v247
v_mul_f32 v181, 0.15915494309189532, v181
v_lshlrev_b32 v222, 4, v155
s_waitcnt lgkmcnt(6)
v_mfma_f32_32x32x16_bf16 v[160:175], v[36:39], v[132:135], v[160:175]
ds_read_b128 v[132:135], v249 offset:32768
buffer_load_dwordx4 v8, s[12:15], s91 offen offset:1024 lds
ds_read_b128 v[52:55], v209 offset:2048
v_exp_f32 v180, v180
v_lshl_add_u32 v222, v156, 8, v222
s_waitcnt lgkmcnt(6)
v_mfma_f32_32x32x16_bf16 v[160:175], v[40:43], v[136:139], v[160:175]
ds_read_b128 v[136:139], v250 offset:32768
buffer_load_dwordx4 v7, s[8:11], s92 offen offset:2048 lds
ds_read_b128 v[56:59], v210 offset:2048
v_fract_f32 v181, v181
v_lshl_add_u32 v222, v148, 6, v222
s_cmp_eq_u32 s88, 3
s_cselect_b32 s44, 2102868, s44
s_cselect_b32 s98, 6562053, s98
s_waitcnt lgkmcnt(6)
v_mfma_f32_32x32x16_bf16 v[160:175], v[44:47], v[140:143], v[160:175]
ds_read_b128 v[140:143], v251 offset:32768
buffer_load_dwordx4 v8, s[12:15], s92 offen offset:3072 lds
ds_read_b128 v[60:63], v211 offset:2048
v_cos_f32 v183, v181
v_lshl_add_u32 v222, s86, 9, v222
s_waitcnt vmcnt(15)
s_barrier
s_waitcnt lgkmcnt(6)
v_mfma_f32_32x32x16_bf16 v[160:175], v[48:51], v[128:131], v[160:175]
s_add_u32 m0, s90, 16384
s_add_u32 s91, s62, 0
s_add_u32 s92, s62, 4294965376
ds_read_b128 v[128:131], v248 offset:49152
buffer_load_dwordx4 v5, s[16:19], s91 offen offset:0 lds
ds_read_b128 v[64:67], v208 offset:3072
v_sin_f32 v184, v181
v_lshl_add_u32 v218, v154, 3, v146
v_add_f32 v182, v182, v182
s_waitcnt lgkmcnt(6)
v_mfma_f32_32x32x16_bf16 v[160:175], v[52:55], v[132:135], v[160:175]
ds_read_b128 v[132:135], v249 offset:49152
buffer_load_dwordx4 v6, s[16:19], s91 offen offset:1024 lds
ds_read_b128 v[68:71], v209 offset:3072
v_mul_f32 v9, v183, v180
v_lshl_add_u32 v193, v147, 30, v222
s_cmp_eq_u32 s88, 4
s_cselect_b32 s44, 6627587, s44
s_cselect_b32 s98, 3477602, s98
s_waitcnt lgkmcnt(6)
v_mfma_f32_32x32x16_bf16 v[160:175], v[56:59], v[136:139], v[160:175]
ds_read_b128 v[136:139], v250 offset:49152
buffer_load_dwordx4 v5, s[16:19], s92 offen offset:2048 lds
ds_read_b128 v[72:75], v210 offset:3072
v_mul_f32 v184, v184, v180
v_lshl_add_u32 v218, s85, 4, v218
v_add_f32 v183, -1.0, v9
s_add_u32 s94, s94, 32768
s_waitcnt lgkmcnt(6)
v_mfma_f32_32x32x16_bf16 v[160:175], v[60:63], v[140:143], v[160:175]
ds_read_b128 v[140:143], v251 offset:49152
buffer_load_dwordx4 v6, s[16:19], s92 offen offset:3072 lds
ds_read_b128 v[76:79], v211 offset:3072
v_xor_b32 v10, v179, v184
v_bfe_u32 v156, v218, 1, 2
v_mul_f32 v185, v183, v176
v_and_b32 v157, 1, v144
s_waitcnt vmcnt(12)
s_barrier
s_waitcnt lgkmcnt(6)
v_mfma_f32_32x32x16_bf16 v[160:175], v[64:67], v[128:131], v[160:175]
s_add_u32 m0, s90, 32768
s_add_u32 s91, s62, 229376
s_add_u32 s92, s62, 227456
ds_read_b128 v[128:131], v252 offset:0
buffer_load_dwordx4 v5, s[16:19], s91 offen offset:0 lds
ds_read_b128 v[80:83], v208 offset:4096
v_mul_f32 v186, v183, v177
v_xor_b32 v156, v147, v156
s_cmp_eq_u32 s88, 5
s_cselect_b32 s44, 4600336, s44
s_cselect_b32 s98, 4588321, s98
v_fmac_f32 v185, v184, v177
s_waitcnt lgkmcnt(6)
v_mfma_f32_32x32x16_bf16 v[160:175], v[68:71], v[132:135], v[160:175]
ds_read_b128 v[132:135], v253 offset:0
buffer_load_dwordx4 v6, s[16:19], s91 offen offset:1024 lds
ds_read_b128 v[84:87], v209 offset:4096
v_fma_f32 v186, -v184, v176, v186
v_lshl_add_u32 v218, v218, 6, s94
v_mul_f32 v185, v185, v182
s_waitcnt lgkmcnt(6)
v_mfma_f32_32x32x16_bf16 v[160:175], v[72:75], v[136:139], v[160:175]
ds_read_b128 v[136:139], v254 offset:0
buffer_load_dwordx4 v5, s[16:19], s92 offen offset:2048 lds
ds_read_b128 v[88:91], v210 offset:4096
v_mul_f32 v227, v186, v182
v_lshl_add_u32 v218, v156, 4, v218
v_xor_b32 v226, v179, v185
s_waitcnt lgkmcnt(6)
v_mfma_f32_32x32x16_bf16 v[160:175], v[76:79], v[140:143], v[160:175]
ds_read_b128 v[140:143], v255 offset:0
buffer_load_dwordx4 v6, s[16:19], s92 offen offset:3072 lds
ds_read_b128 v[92:95], v211 offset:4096
v_mul_f32 v187, v10, v10
v_xor_b32 v156, v158, v157
s_cmp_eq_u32 s88, 6
s_cselect_b32 s44, 5505825, s44
s_cselect_b32 s98, 5456400, s98
v_add_f32 v188, v9, v9
s_waitcnt vmcnt(12)
s_barrier
s_waitcnt lgkmcnt(6)
v_mfma_f32_32x32x16_bf16 v[160:175], v[80:83], v[128:131], v[160:175]
s_add_u32 m0, s90, 49152
s_add_u32 s91, s62, 458752
s_add_u32 s92, s62, 456832
ds_read_b128 v[128:131], v252 offset:16384
buffer_load_dwordx4 v5, s[16:19], s91 offen offset:0 lds
ds_read_b128 v[96:99], v208 offset:5120
v_fma_f32 v180, v9, v9, -v187
v_lshl_add_u32 v218, v157, 12, v218
v_mul_f32 v181, v188, v10
v_lshl_add_u32 v156, v154, 1, v156
s_waitcnt lgkmcnt(6)
v_mfma_f32_32x32x16_bf16 v[160:175], v[84:87], v[132:135], v[160:175]
ds_read_b128 v[132:135], v253 offset:16384
buffer_load_dwordx4 v6, s[16:19], s91 offen offset:1024 lds
ds_read_b128 v[100:103], v209 offset:5120
v_mul_f32 v187, v181, v181
v_bfe_u32 v157, v0, 1, 1
v_add_f32 v188, v180, v180
s_waitcnt lgkmcnt(6)
v_mfma_f32_32x32x16_bf16 v[160:175], v[88:91], v[136:139], v[160:175]
ds_read_b128 v[136:139], v254 offset:16384
buffer_load_dwordx4 v5, s[16:19], s92 offen offset:2048 lds
ds_read_b128 v[104:107], v210 offset:5120
v_fma_f32 v182, v180, v180, -v187
v_lshl_add_u32 v219, v147, 9, s94
s_bitcmp1_b32 s87, 2
s_cselect_b32 s44, s98, s44
v_mul_f32 v183, v188, v181
s_waitcnt lgkmcnt(6)
v_mfma_f32_32x32x16_bf16 v[160:175], v[92:95], v[140:143], v[160:175]
ds_read_b128 v[140:143], v255 offset:16384
buffer_load_dwordx4 v6, s[16:19], s92 offen offset:3072 lds
ds_read_b128 v[108:111], v211 offset:5120
v_mul_f32 v187, v183, v183
v_lshl_add_u32 v156, v156, 1, v157
v_add_f32 v188, v182, v182
s_waitcnt vmcnt(12)
s_barrier
s_waitcnt lgkmcnt(6)
v_mfma_f32_32x32x16_bf16 v[160:175], v[96:99], v[128:131], v[160:175]
s_add_u32 m0, s90, 65536
s_add_u32 s91, s62, 688128
s_add_u32 s92, s62, 686208
ds_read_b128 v[128:131], v248 offset:0
buffer_load_dwordx4 v5, s[16:19], s91 offen offset:0 lds
ds_read_b128 v[112:115], v208 offset:6144
v_fma_f32 v11, v182, v182, -v187
v_lshl_add_u32 v219, v152, 6, v219
s_and_b32 s2, s85, 2
v_mul_f32 v12, v188, v183
s_and_b32 s94, s85, 1
s_lshl_b32 s95, s86, 1
s_waitcnt lgkmcnt(6)
v_mfma_f32_32x32x16_bf16 v[160:175], v[100:103], v[132:135], v[160:175]
ds_read_b128 v[132:135], v249 offset:0
buffer_load_dwordx4 v6, s[16:19], s91 offen offset:1024 lds
ds_read_b128 v[116:119], v209 offset:6144
v_mul_f32 v187, v12, v12
s_add_u32 s94, s94, s95
s_lshl_b32 s2, s2, 1
v_add_f32 v188, v11, v11
s_lshl_b32 s94, s94, 11
v_lshl_add_u32 v219, v156, 3, v219
s_waitcnt lgkmcnt(6)
v_mfma_f32_32x32x16_bf16 v[160:175], v[104:107], v[136:139], v[160:175]
ds_read_b128 v[136:139], v250 offset:0
buffer_load_dwordx4 v5, s[16:19], s92 offen offset:2048 lds
ds_read_b128 v[120:123], v210 offset:6144
v_fma_f32 v13, v11, v11, -v187
v_lshl_add_u32 v221, v0, 4, s94
s_lshr_b32 s2, s44, s2
v_mul_f32 v14, v188, v12
s_waitcnt lgkmcnt(6)
v_mfma_f32_32x32x16_bf16 v[160:175], v[108:111], v[140:143], v[160:175]
ds_read_b128 v[140:143], v251 offset:0
buffer_load_dwordx4 v6, s[16:19], s92 offen offset:3072 lds
ds_read_b128 v[124:127], v211 offset:6144
v_cndmask_b32 v224, 1.0, v13, s[96:97]
v_xor_b32 v220, 0x120, v219
s_bfe_u32 s37, s2, 0x30010
v_cndmask_b32 v225, 0, v14, s[96:97]
s_waitcnt vmcnt(12)
s_barrier
s_waitcnt lgkmcnt(6)
v_mfma_f32_32x32x16_bf16 v[160:175], v[112:115], v[128:131], v[160:175]
s_add_u32 m0, s90, 81920
s_add_u32 s91, s62, 917504
s_add_u32 s92, s62, 915584
ds_read_b64_tr_b16 v[128:129], v1 offset:16384
ds_read_b64_tr_b16 v[130:131], v1 offset:17408
buffer_load_dwordx4 v5, s[16:19], s91 offen offset:0 lds
s_cmp_ge_u32 s85, 2
s_cselect_b64 s[80:81], s[28:29], s[24:25]
s_waitcnt lgkmcnt(6)
v_mfma_f32_32x32x16_bf16 v[160:175], v[116:119], v[132:135], v[160:175]
ds_read_b64_tr_b16 v[132:133], v1 offset:20480
ds_read_b64_tr_b16 v[134:135], v1 offset:21504
buffer_load_dwordx4 v6, s[16:19], s91 offen offset:1024 lds
ds_read_b64_tr_b16 v[230:231], v195
s_lshl_b32 s99, s88, 3
ds_read_b64_tr_b16 v[232:233], v196 offset:7168
s_waitcnt lgkmcnt(8)
v_mfma_f32_32x32x16_bf16 v[160:175], v[120:123], v[136:139], v[160:175]
ds_read_b64_tr_b16 v[136:137], v1 offset:24576
ds_read_b64_tr_b16 v[138:139], v1 offset:25600
buffer_load_dwordx4 v5, s[16:19], s92 offen offset:2048 lds
s_add_u32 s99, s99, s85
s_waitcnt lgkmcnt(8)
v_mfma_f32_32x32x16_bf16 v[160:175], v[124:127], v[140:143], v[160:175]
ds_read_b64_tr_b16 v[140:141], v1 offset:28672
ds_read_b64_tr_b16 v[142:143], v1 offset:29696
buffer_load_dwordx4 v6, s[16:19], s92 offen offset:3072 lds
s_mul_i32 s99, s99, 28672
s_waitcnt vmcnt(12)
s_barrier
s_waitcnt lgkmcnt(8)
v_mfma_f32_32x32x16_bf16 v[144:159], v[128:131], v[16:19], 0
s_add_u32 m0, s90, 0
s_add_u32 s91, s62, 1146880
s_add_u32 s92, s62, 1144960
ds_read_b64_tr_b16 v[128:129], v1 offset:32768
ds_read_b64_tr_b16 v[130:131], v1 offset:33792
buffer_load_dwordx4 v5, s[16:19], s91 offen offset:0 lds
v_fma_f32 v238, v9, v160, v161
s_add_u32 s52, s99, 2048
v_fma_f32 v240, v9, v168, v169
v_fmac_f32_dpp v238, v160, -v10 row_ror:8 row_mask:0xf bank_mask:0xf
s_nop 0
v_fmac_f32_dpp v240, v168, -v10 row_ror:8 row_mask:0xf bank_mask:0xf
v_fma_f32 v239, v9, v238, v162
s_waitcnt lgkmcnt(8)
v_mfma_f32_32x32x16_bf16 v[144:159], v[132:135], v[20:23], v[144:159]
ds_read_b64_tr_b16 v[132:133], v1 offset:36864
ds_read_b64_tr_b16 v[134:135], v1 offset:37888
buffer_load_dwordx4 v6, s[16:19], s91 offen offset:1024 lds
v_fma_f32 v241, v9, v240, v170
s_lshl_b32 s98, s88, 7
v_fmac_f32_dpp v239, v238, -v10 row_ror:8 row_mask:0xf bank_mask:0xf
s_add_u32 s54, s52, s98
v_fmac_f32_dpp v241, v240, -v10 row_ror:8 row_mask:0xf bank_mask:0xf
v_fma_f32 v238, v9, v239, v163
v_fma_f32 v240, v9, v241, v171
s_waitcnt lgkmcnt(6)
v_mfma_f32_32x32x16_bf16 v[144:159], v[136:139], v[24:27], v[144:159]
ds_read_b64_tr_b16 v[136:137], v1 offset:40960
ds_read_b64_tr_b16 v[138:139], v1 offset:41984
buffer_load_dwordx4 v5, s[16:19], s92 offen offset:2048 lds
v_fmac_f32_dpp v238, v239, -v10 row_ror:8 row_mask:0xf bank_mask:0xf
s_bfe_u32 s98, s44, 196608
v_fmac_f32_dpp v240, v241, -v10 row_ror:8 row_mask:0xf bank_mask:0xf
v_fma_f32 v239, v9, v238, v164
v_fma_f32 v241, v9, v240, v172
s_nop 0
v_fmac_f32_dpp v239, v238, -v10 row_ror:8 row_mask:0xf bank_mask:0xf
s_waitcnt lgkmcnt(6)
v_mfma_f32_32x32x16_bf16 v[144:159], v[140:143], v[28:31], v[144:159]
ds_read_b64_tr_b16 v[140:141], v1 offset:45056
ds_read_b64_tr_b16 v[142:143], v1 offset:46080
buffer_load_dwordx4 v6, s[16:19], s92 offen offset:3072 lds
v_fmac_f32_dpp v241, v240, -v10 row_ror:8 row_mask:0xf bank_mask:0xf
buffer_load_dwordx4 v[234:237], v222, s[32:35], s75 offen sc1
s_lshl_b32 s98, s98, 7
v_fma_f32 v238, v9, v239, v165
buffer_load_dwordx4 v[208:211], v193, s[32:35], s36 offen sc1
v_fma_f32 v240, v9, v241, v173
v_fmac_f32_dpp v238, v239, -v10 row_ror:8 row_mask:0xf bank_mask:0xf
s_nop 0
v_fmac_f32_dpp v240, v241, -v10 row_ror:8 row_mask:0xf bank_mask:0xf
s_waitcnt vmcnt(14)
s_barrier
s_waitcnt lgkmcnt(6)
v_mfma_f32_32x32x16_bf16 v[144:159], v[128:131], v[32:35], v[144:159]
s_add_u32 m0, s90, 16384
s_add_u32 s91, s62, 1376256
s_add_u32 s92, s62, 1374336
ds_read_b64_tr_b16 v[128:129], v1 offset:49152
ds_read_b64_tr_b16 v[130:131], v1 offset:50176
buffer_load_dwordx4 v5, s[16:19], s91 offen offset:0 lds
v_fma_f32 v239, v9, v238, v166
s_add_u32 s48, s52, s98
v_fma_f32 v241, v9, v240, v174
s_bfe_u32 s98, s44, 196612
v_fmac_f32_dpp v239, v238, -v10 row_ror:8 row_mask:0xf bank_mask:0xf
v_fmac_f32_dpp v241, v240, -v10 row_ror:8 row_mask:0xf bank_mask:0xf
v_fma_f32 v238, v9, v239, v167
s_waitcnt lgkmcnt(6)
v_mfma_f32_32x32x16_bf16 v[144:159], v[132:135], v[36:39], v[144:159]
ds_read_b64_tr_b16 v[132:133], v1 offset:53248
ds_read_b64_tr_b16 v[134:135], v1 offset:54272
buffer_load_dwordx4 v6, s[16:19], s91 offen offset:1024 lds
v_fma_f32 v240, v9, v241, v175
s_lshl_b32 s98, s98, 7
v_fmac_f32_dpp v238, v239, -v10 row_ror:8 row_mask:0xf bank_mask:0xf
v_fmac_f32_dpp v240, v241, -v10 row_ror:8 row_mask:0xf bank_mask:0xf
v_fma_f32 v245, v11, v238, v240
v_mul_f32_dpp v246, v238, v227 row_ror:8 row_mask:0xf bank_mask:0xf
s_waitcnt lgkmcnt(6)
v_mfma_f32_32x32x16_bf16 v[144:159], v[136:139], v[40:43], v[144:159]
ds_read_b64_tr_b16 v[136:137], v1 offset:57344
ds_read_b64_tr_b16 v[138:139], v1 offset:58368
buffer_load_dwordx4 v5, s[16:19], s92 offen offset:2048 lds
v_fmac_f32_dpp v245, v238, -v12 row_ror:8 row_mask:0xf bank_mask:0xf
s_add_u32 s49, s99, s98
v_fma_f32 v242, v226, v238, v246
v_mul_f32 v244, v226, v245
s_nop 1
v_fmac_f32_dpp v244, v245, v227 row_ror:8 row_mask:0xf bank_mask:0xf
v_mov_b32 v223, v244
s_waitcnt lgkmcnt(6)
v_mfma_f32_32x32x16_bf16 v[144:159], v[140:143], v[44:47], v[144:159]
ds_read_b64_tr_b16 v[140:141], v1 offset:61440
ds_read_b64_tr_b16 v[142:143], v1 offset:62464
buffer_load_dwordx4 v6, s[16:19], s92 offen offset:3072 lds
v_permlane32_swap_b32 v244, v223
s_bfe_u32 s98, s44, 196616
v_fma_f32 v223, v13, v244, v223
s_nop 1
v_fmac_f32_dpp v223, v244, v14 row_ror:8 row_mask:0xf bank_mask:0xf
ds_write_b32 v247, v223 offset:1024
v_cndmask_b32 v243, 0, v244, s[96:97]
s_waitcnt vmcnt(14) lgkmcnt(0)
s_barrier
v_mfma_f32_32x32x16_bf16 v[144:159], v[128:131], v[48:51], v[144:159]
s_add_u32 m0, s90, 32768
s_add_u32 s91, s62, 256
s_add_u32 s92, s62, 4294965632
ds_read_b64_tr_b16 v[128:129], v2 offset:0
ds_read_b64_tr_b16 v[130:131], v2 offset:1024
buffer_load_dwordx4 v5, s[16:19], s91 offen offset:0 lds
s_lshl_b32 s98, s98, 7
s_add_u32 s50, s52, s98
v_mfma_f32_32x32x16_bf16 v[144:159], v[132:135], v[52:55], v[144:159]
ds_read_b64_tr_b16 v[132:133], v2 offset:4096
ds_read_b64_tr_b16 v[134:135], v2 offset:5120
buffer_load_dwordx4 v6, s[16:19], s91 offen offset:1024 lds
s_bfe_u32 s98, s44, 196620
v_mfma_f32_32x32x16_bf16 v[144:159], v[136:139], v[56:59], v[144:159]
ds_read_b64_tr_b16 v[136:137], v2 offset:8192
ds_read_b64_tr_b16 v[138:139], v2 offset:9216
buffer_load_dwordx4 v5, s[16:19], s92 offen offset:2048 lds
s_lshl_b32 s98, s98, 7
v_mfma_f32_32x32x16_bf16 v[144:159], v[140:143], v[60:63], v[144:159]
ds_read_b64_tr_b16 v[140:141], v2 offset:12288
ds_read_b64_tr_b16 v[142:143], v2 offset:13312
buffer_load_dwordx4 v6, s[16:19], s92 offen offset:3072 lds
buffer_load_dwordx4 v[212:215], v194, s[32:35], s74 offen offset:0 sc1
s_add_u32 s51, s99, s98
s_waitcnt vmcnt(15)
s_barrier
s_waitcnt lgkmcnt(6)
v_mfma_f32_32x32x16_bf16 v[144:159], v[128:131], v[64:67], v[144:159]
s_add_u32 m0, s90, 49152
s_add_u32 s91, s62, 229632
s_add_u32 s92, s62, 227712
ds_read_b64_tr_b16 v[128:129], v2 offset:16384
ds_read_b64_tr_b16 v[130:131], v2 offset:17408
buffer_load_dwordx4 v5, s[16:19], s91 offen offset:0 lds
v_mul_f32_dpp v245, v160, v227 row_ror:8 row_mask:0xf bank_mask:0xf
s_bfe_u32 s98, s44, 196624
v_mul_f32_dpp v246, v161, v227 row_ror:8 row_mask:0xf bank_mask:0xf
s_lshl_b32 s98, s98, 7
s_waitcnt lgkmcnt(6)
v_mfma_f32_32x32x16_bf16 v[144:159], v[132:135], v[68:71], v[144:159]
ds_read_b64_tr_b16 v[132:133], v2 offset:20480
ds_read_b64_tr_b16 v[134:135], v2 offset:21504
buffer_load_dwordx4 v6, s[16:19], s91 offen offset:1024 lds
v_fma_f32 v160, v226, v160, v245
s_add_u32 s52, s52, s98
v_fma_f32 v161, v226, v161, v246
s_waitcnt lgkmcnt(6)
v_mfma_f32_32x32x16_bf16 v[144:159], v[136:139], v[72:75], v[144:159]
ds_read_b64_tr_b16 v[136:137], v2 offset:24576
ds_read_b64_tr_b16 v[138:139], v2 offset:25600
buffer_load_dwordx4 v5, s[16:19], s92 offen offset:2048 lds
v_mul_f32_dpp v245, v162, v227 row_ror:8 row_mask:0xf bank_mask:0xf
s_bfe_u32 s98, s44, 196628
v_mul_f32_dpp v246, v163, v227 row_ror:8 row_mask:0xf bank_mask:0xf
s_waitcnt lgkmcnt(6)
v_mfma_f32_32x32x16_bf16 v[144:159], v[140:143], v[76:79], v[144:159]
ds_read_b64_tr_b16 v[140:141], v2 offset:28672
ds_read_b64_tr_b16 v[142:143], v2 offset:29696
buffer_load_dwordx4 v6, s[16:19], s92 offen offset:3072 lds
v_fma_f32 v162, v226, v162, v245
s_lshl_b32 s98, s98, 7
v_fma_f32 v163, v226, v163, v246
s_add_u32 s53, s99, s98
s_waitcnt vmcnt(15)
s_barrier
s_waitcnt lgkmcnt(6)
v_mfma_f32_32x32x16_bf16 v[144:159], v[128:131], v[80:83], v[144:159]
s_add_u32 m0, s90, 65536
s_add_u32 s91, s62, 459008
s_add_u32 s92, s62, 457088
ds_read_b64_tr_b16 v[128:129], v1 offset:0
ds_read_b64_tr_b16 v[130:131], v1 offset:1024
buffer_load_dwordx4 v5, s[16:19], s91 offen offset:0 lds
v_mul_f32_dpp v245, v164, v227 row_ror:8 row_mask:0xf bank_mask:0xf
s_and_b32 s99, s85, 1
v_mul_f32_dpp v246, v165, v227 row_ror:8 row_mask:0xf bank_mask:0xf
s_waitcnt lgkmcnt(6)
v_mfma_f32_32x32x16_bf16 v[144:159], v[132:135], v[84:87], v[144:159]
ds_read_b64_tr_b16 v[132:133], v1 offset:4096
ds_read_b64_tr_b16 v[134:135], v1 offset:5120
buffer_load_dwordx4 v6, s[16:19], s91 offen offset:1024 lds
s_waitcnt vmcnt(16)
v_cmp_ne_u32 vcc, s89, v237
s_waitcnt vmcnt(15)
v_cmp_ne_u32 s[40:41], s89, v211
s_nop 0
s_or_b32 s40, s40, vcc_lo
s_cbranch_scc1 RSTL
BSTL:
v_fma_f32 v164, v226, v164, v245
s_mul_i32 s99, s99, 28672
v_mul_f32 v223, v234, v234
v_fma_f32 v165, v226, v165, v246
v_lshrrev_b32 v222, 2, v222
v_mul_f32 v223, 0x3c0a3963, v223
ds_write_b32 v222, v236 offset:0
v_mov_b32 v211, 0
v_mul_f32 v237, v223, v234
s_waitcnt lgkmcnt(7)
v_mfma_f32_32x32x16_bf16 v[144:159], v[136:139], v[88:91], v[144:159]
ds_read_b64_tr_b16 v[136:137], v1 offset:8192
ds_read_b64_tr_b16 v[138:139], v1 offset:9216
buffer_load_dwordx4 v5, s[16:19], s92 offen offset:2048 lds
v_mul_f32_dpp v245, v166, v227 row_ror:8 row_mask:0xf bank_mask:0xf
s_lshl_b32 s98, s88, 7
v_mul_f32_dpp v246, v167, v227 row_ror:8 row_mask:0xf bank_mask:0xf
s_waitcnt lgkmcnt(7)
v_mfma_f32_32x32x16_bf16 v[144:159], v[140:143], v[92:95], v[144:159]
ds_read_b64_tr_b16 v[140:141], v1 offset:12288
ds_read_b64_tr_b16 v[142:143], v1 offset:13312
buffer_load_dwordx4 v6, s[16:19], s92 offen offset:3072 lds
v_fma_f32 v166, v226, v166, v245
v_min_u32 v199, 6, v0
s_add_u32 s99, s99, s98
v_fma_f32 v167, v226, v167, v246
v_lshlrev_b32 v199, 8, v199
s_mul_i32 s98, s88, 57344
s_lshl_b32 s41, s87, 11
s_add_u32 s41, s41, 655360
buffer_load_dword v198, v199, s[32:35], s41 offen sc1
s_waitcnt vmcnt(14)
s_barrier
s_waitcnt lgkmcnt(7)
v_mfma_f32_32x32x16_bf16 v[144:159], v[128:131], v[96:99], v[144:159]
s_add_u32 m0, s90, 81920
s_add_u32 s91, s62, 688384
s_add_u32 s92, s62, 686464
ds_read_b64_tr_b16 v[128:129], v1 offset:16384
ds_read_b64_tr_b16 v[130:131], v1 offset:17408
buffer_load_dwordx4 v5, s[16:19], s91 offen offset:0 lds
v_mul_f32_dpp v245, v168, v227 row_ror:8 row_mask:0xf bank_mask:0xf
s_add_u32 s58, s99, s98
v_mul_f32_dpp v246, v169, v227 row_ror:8 row_mask:0xf bank_mask:0xf
s_waitcnt lgkmcnt(7)
v_mfma_f32_32x32x16_bf16 v[144:159], v[132:135], v[100:103], v[144:159]
ds_read_b64_tr_b16 v[132:133], v1 offset:20480
ds_read_b64_tr_b16 v[134:135], v1 offset:21504
buffer_load_dwordx4 v6, s[16:19], s91 offen offset:1024 lds
v_fma_f32 v168, v226, v168, v245
s_bfe_u32 s98, s2, 196608
v_fma_f32 v169, v226, v169, v246
s_waitcnt lgkmcnt(6)
v_mfma_f32_32x32x16_bf16 v[144:159], v[136:139], v[104:107], v[144:159]
ds_read_b64_tr_b16 v[136:137], v1 offset:24576
ds_read_b64_tr_b16 v[138:139], v1 offset:25600
buffer_load_dwordx4 v5, s[16:19], s92 offen offset:2048 lds
s_waitcnt vmcnt(12)
v_cmp_ne_u32 vcc, s89, v215
s_nop 0
s_cmp_lg_u64 vcc, 0
s_cbranch_scc1 RCS0L
BCS0L:
v_mul_f32_dpp v245, v170, v227 row_ror:8 row_mask:0xf bank_mask:0xf
s_mul_i32 s98, s98, 57344
v_mov_b32 v215, 0
v_mul_f32_dpp v246, v171, v227 row_ror:8 row_mask:0xf bank_mask:0xf
s_add_u32 s55, s98, s99
s_waitcnt lgkmcnt(6)
v_mfma_f32_32x32x16_bf16 v[144:159], v[140:143], v[108:111], v[144:159]
ds_read_b64_tr_b16 v[140:141], v1 offset:28672
ds_read_b64_tr_b16 v[142:143], v1 offset:29696
buffer_load_dwordx4 v6, s[16:19], s92 offen offset:3072 lds
v_fma_f32 v170, v226, v170, v245
s_bfe_u32 s98, s2, 196616
v_fma_f32 v171, v226, v171, v246
s_barrier
s_waitcnt lgkmcnt(6)
v_mfma_f32_32x32x16_bf16 v[144:159], v[128:131], v[112:115], v[144:159]
s_add_u32 m0, s90, 0
s_add_u32 s91, s62, 917760
s_add_u32 s92, s62, 915840
ds_read_b64_tr_b16 v[128:129], v1 offset:32768
ds_read_b64_tr_b16 v[130:131], v1 offset:33792
buffer_load_dwordx4 v5, s[16:19], s91 offen offset:0 lds
v_mul_f32_dpp v245, v172, v227 row_ror:8 row_mask:0xf bank_mask:0xf
s_mul_i32 s98, s98, 57344
v_mul_f32_dpp v246, v173, v227 row_ror:8 row_mask:0xf bank_mask:0xf
s_waitcnt lgkmcnt(6)
v_mfma_f32_32x32x16_bf16 v[144:159], v[132:135], v[116:119], v[144:159]
ds_read_b64_tr_b16 v[132:133], v1 offset:36864
ds_read_b64_tr_b16 v[134:135], v1 offset:37888
PADL1:
s_cbranch_execz HOPB
buffer_load_dwordx4 v6, s[16:19], s91 offen offset:1024 lds
v_mfma_f32_32x32x16_bf16 v[144:159], v[212:215], v[208:211], v[144:159]
v_fma_f32 v172, v226, v172, v245
s_add_u32 s56, s98, s99
v_fma_f32 v173, v226, v173, v246
s_waitcnt lgkmcnt(6)
v_mfma_f32_32x32x16_bf16 v[144:159], v[136:139], v[120:123], v[144:159]
ds_read_b64_tr_b16 v[136:137], v1 offset:40960
ds_read_b64_tr_b16 v[138:139], v1 offset:41984
buffer_load_dwordx4 v5, s[16:19], s92 offen offset:2048 lds
v_mul_f32_dpp v245, v174, v227 row_ror:8 row_mask:0xf bank_mask:0xf
s_bfe_u32 s98, s2, 196624
v_mul_f32_dpp v246, v175, v227 row_ror:8 row_mask:0xf bank_mask:0xf
s_mul_i32 s98, s98, 57344
s_waitcnt lgkmcnt(6)
v_mfma_f32_32x32x16_bf16 v[144:159], v[140:143], v[124:127], v[144:159]
ds_read_b64_tr_b16 v[140:141], v1 offset:45056
ds_read_b64_tr_b16 v[142:143], v1 offset:46080
buffer_load_dwordx4 v6, s[16:19], s92 offen offset:3072 lds
v_fma_f32 v174, v226, v174, v245
s_add_u32 s57, s98, s99
v_fma_f32 v175, v226, v175, v246
s_waitcnt vmcnt(13)
s_barrier
s_waitcnt lgkmcnt(6)
v_mfma_f32_32x32x16_bf16 v[176:191], v[128:131], v[16:19], 0
s_add_u32 m0, s90, 16384
s_add_u32 s91, s62, 1147136
s_add_u32 s92, s62, 1145216
ds_read_b64_tr_b16 v[128:129], v1 offset:49152
ds_read_b64_tr_b16 v[130:131], v1 offset:50176
buffer_load_dwordx4 v5, s[16:19], s91 offen offset:0 lds
v_mul_f32 v238, v144, v144
v_mul_f32 v239, v145, v145
v_mul_f32 v240, v146, v146
v_mul_f32 v241, v147, v147
v_fma_f32 v238, v238, v237, v234
s_waitcnt lgkmcnt(6)
v_mfma_f32_32x32x16_bf16 v[176:191], v[132:135], v[20:23], v[176:191]
ds_read_b64_tr_b16 v[132:133], v1 offset:53248
ds_read_b64_tr_b16 v[134:135], v1 offset:54272
buffer_load_dwordx4 v6, s[16:19], s91 offen offset:1024 lds
v_fma_f32 v239, v239, v237, v234
v_fma_f32 v240, v240, v237, v234
v_fma_f32 v241, v241, v237, v234
v_mul_f32 v238, v238, v144
v_mul_f32 v239, v239, v145
v_mul_f32 v240, v240, v146
s_waitcnt lgkmcnt(6)
v_mfma_f32_32x32x16_bf16 v[176:191], v[136:139], v[24:27], v[176:191]
ds_read_b64_tr_b16 v[136:137], v1 offset:57344
ds_read_b64_tr_b16 v[138:139], v1 offset:58368
buffer_load_dwordx4 v5, s[16:19], s92 offen offset:2048 lds
v_mul_f32 v241, v241, v147
v_exp_f32 v238, v238
v_exp_f32 v239, v239
s_waitcnt lgkmcnt(6)
v_mfma_f32_32x32x16_bf16 v[176:191], v[140:143], v[28:31], v[176:191]
ds_read_b64_tr_b16 v[140:141], v1 offset:61440
ds_read_b64_tr_b16 v[142:143], v1 offset:62464
buffer_load_dwordx4 v6, s[16:19], s92 offen offset:3072 lds
v_exp_f32 v240, v240
buffer_load_dwordx4 v[212:215], v194, s[32:35], s74 offen offset:2048 sc1
v_exp_f32 v241, v241
v_fma_f32 v238, v238, v235, v235
v_fma_f32 v239, v239, v235, v235
s_waitcnt vmcnt(14)
s_barrier
s_waitcnt lgkmcnt(6)
v_mfma_f32_32x32x16_bf16 v[176:191], v[128:131], v[32:35], v[176:191]
s_add_u32 m0, s90, 32768
s_add_u32 s91, s62, 1376512
s_add_u32 s92, s62, 1374592
ds_read_b64_tr_b16 v[128:129], v2 offset:0
ds_read_b64_tr_b16 v[130:131], v2 offset:1024
buffer_load_dwordx4 v5, s[16:19], s91 offen offset:0 lds
v_fma_f32 v240, v240, v235, v235
v_fma_f32 v241, v241, v235, v235
v_rcp_f32 v238, v238
v_rcp_f32 v239, v239
s_waitcnt lgkmcnt(6)
v_mfma_f32_32x32x16_bf16 v[176:191], v[132:135], v[36:39], v[176:191]
ds_read_b64_tr_b16 v[132:133], v2 offset:4096
ds_read_b64_tr_b16 v[134:135], v2 offset:5120
buffer_load_dwordx4 v6, s[16:19], s91 offen offset:1024 lds
v_rcp_f32 v240, v240
v_rcp_f32 v241, v241
v_mul_f32 v238, v238, v144
s_waitcnt lgkmcnt(6)
v_mfma_f32_32x32x16_bf16 v[176:191], v[136:139], v[40:43], v[176:191]
ds_read_b64_tr_b16 v[136:137], v2 offset:8192
ds_read_b64_tr_b16 v[138:139], v2 offset:9216
buffer_load_dwordx4 v5, s[16:19], s92 offen offset:2048 lds
v_mul_f32 v239, v239, v145
v_mul_f32 v240, v240, v146
v_mul_f32 v241, v241, v147
v_cvt_pk_bf16_f32 v144, v238, v239
v_cvt_pk_bf16_f32 v145, v240, v241
s_waitcnt lgkmcnt(6)
v_mfma_f32_32x32x16_bf16 v[176:191], v[140:143], v[44:47], v[176:191]
ds_read_b64_tr_b16 v[140:141], v2 offset:12288
ds_read_b64_tr_b16 v[142:143], v2 offset:13312
buffer_load_dwordx4 v6, s[16:19], s92 offen offset:3072 lds
v_mul_f32 v238, v148, v148
s_movk_i32 s92, 896
v_mul_f32 v239, v149, v149
v_lshrrev_b32 v6, 3, v0
v_mul_f32 v240, v150, v150
v_and_b32 v5, 0x70, v5
v_mul_f32 v241, v151, v151
v_mad_u32_u24 v5, v6, s92, v5
v_fma_f32 v238, v238, v237, v234
v_add_u32 v6, 6144, v5
s_waitcnt vmcnt(13)
s_barrier
s_waitcnt lgkmcnt(6)
v_mfma_f32_32x32x16_bf16 v[176:191], v[128:131], v[48:51], v[176:191]
s_add_u32 m0, s90, 49152
s_add_u32 s91, s48, 0
s_add_u32 s92, s49, 0
ds_read_b64_tr_b16 v[128:129], v2 offset:16384
ds_read_b64_tr_b16 v[130:131], v2 offset:17408
buffer_load_dwordx4 v5, s[20:23], s91 offen offset:0 lds
v_fma_f32 v239, v239, v237, v234
v_fma_f32 v240, v240, v237, v234
v_fma_f32 v241, v241, v237, v234
v_mul_f32 v238, v238, v148
v_mul_f32 v239, v239, v149
v_mul_f32 v240, v240, v150
s_waitcnt lgkmcnt(6)
v_mfma_f32_32x32x16_bf16 v[176:191], v[132:135], v[52:55], v[176:191]
ds_read_b64_tr_b16 v[132:133], v2 offset:20480
ds_read_b64_tr_b16 v[134:135], v2 offset:21504
buffer_load_dwordx4 v6, s[20:23], s91 offen offset:1024 lds
v_mul_f32 v241, v241, v151
v_exp_f32 v238, v238
v_exp_f32 v239, v239
s_waitcnt lgkmcnt(6)
v_mfma_f32_32x32x16_bf16 v[176:191], v[136:139], v[56:59], v[176:191]
ds_read_b64_tr_b16 v[136:137], v2 offset:24576
ds_read_b64_tr_b16 v[138:139], v2 offset:25600
buffer_load_dwordx4 v5, s[20:23], s92 offen offset:2048 lds
v_exp_f32 v240, v240
v_xor_b32 v199, s89, v198
v_cmp_lt_u32 vcc, 15, v199
s_nop 0
s_cmp_lg_u64 vcc, 0
s_cbranch_scc1 RXCL
BXCL:
v_exp_f32 v241, v241
v_readlane_b32 s71, v198, s37
s_nop 0
s_cmp_eq_u32 s71, s45
s_cselect_b32 s39, 1, 0
v_fma_f32 v238, v238, v235, v235
v_fma_f32 v239, v239, v235, v235
s_waitcnt lgkmcnt(6)
v_mfma_f32_32x32x16_bf16 v[176:191], v[140:143], v[60:63], v[176:191]
ds_read_b64_tr_b16 v[140:141], v2 offset:28672
ds_read_b64_tr_b16 v[142:143], v2 offset:29696
buffer_load_dwordx4 v6, s[20:23], s92 offen offset:3072 lds
v_fma_f32 v240, v240, v235, v235
v_fma_f32 v241, v241, v235, v235
v_rcp_f32 v238, v238
v_rcp_f32 v239, v239
s_waitcnt vmcnt(9)
s_barrier
s_waitcnt lgkmcnt(6)
v_mfma_f32_32x32x16_bf16 v[176:191], v[128:131], v[64:67], v[176:191]
s_add_u32 m0, s90, 65536
s_add_u32 s91, s50, 0
s_add_u32 s92, s51, 0
ds_read_b64_tr_b16 v[128:129], v1 offset:0
ds_read_b64_tr_b16 v[130:131], v1 offset:1024
ds_read_b64_tr_b16 v[32:33], v1 offset:16384
ds_read_b64_tr_b16 v[34:35], v1 offset:17408
buffer_load_dwordx4 v5, s[20:23], s91 offen offset:0 lds
v_rcp_f32 v240, v240
v_rcp_f32 v241, v241
v_mul_f32 v238, v238, v148
s_waitcnt lgkmcnt(8)
v_mfma_f32_32x32x16_bf16 v[176:191], v[132:135], v[68:71], v[176:191]
ds_read_b64_tr_b16 v[132:133], v1 offset:4096
ds_read_b64_tr_b16 v[134:135], v1 offset:5120
ds_read_b64_tr_b16 v[36:37], v1 offset:20480
ds_read_b64_tr_b16 v[38:39], v1 offset:21504
buffer_load_dwordx4 v6, s[20:23], s91 offen offset:1024 lds
v_mul_f32 v239, v239, v149
v_mul_f32 v240, v240, v150
v_mul_f32 v241, v241, v151
v_cvt_pk_bf16_f32 v146, v238, v239
v_cvt_pk_bf16_f32 v147, v240, v241
s_waitcnt lgkmcnt(10)
v_mfma_f32_32x32x16_bf16 v[176:191], v[136:139], v[72:75], v[176:191]
ds_read_b64_tr_b16 v[136:137], v1 offset:8192
ds_read_b64_tr_b16 v[138:139], v1 offset:9216
ds_read_b64_tr_b16 v[40:41], v1 offset:24576
ds_read_b64_tr_b16 v[42:43], v1 offset:25600
buffer_load_dwordx4 v5, s[20:23], s92 offen offset:2048 lds
v_mul_f32 v238, v152, v152
v_mul_f32 v239, v153, v153
v_mul_f32 v240, v154, v154
v_mul_f32 v241, v155, v155
v_fma_f32 v238, v238, v237, v234
s_waitcnt lgkmcnt(12)
v_mfma_f32_32x32x16_bf16 v[176:191], v[140:143], v[76:79], v[176:191]
ds_read_b64_tr_b16 v[140:141], v1 offset:12288
ds_read_b64_tr_b16 v[142:143], v1 offset:13312
ds_read_b64_tr_b16 v[44:45], v1 offset:28672
ds_read_b64_tr_b16 v[46:47], v1 offset:29696
buffer_load_dwordx4 v6, s[20:23], s92 offen offset:3072 lds
v_fma_f32 v239, v239, v237, v234
v_fma_f32 v240, v240, v237, v234
v_fma_f32 v241, v241, v237, v234
v_mul_f32 v238, v238, v152
v_mul_f32 v239, v239, v153
v_mul_f32 v240, v240, v154
s_barrier
s_waitcnt lgkmcnt(14)
v_mfma_f32_32x32x16_bf16 v[176:191], v[128:131], v[80:83], v[176:191]
s_add_u32 m0, s90, 81920
s_add_u32 s91, s52, 0
s_add_u32 s92, s53, 0
ds_write_b128 v4, v[144:147] offset:0
buffer_load_dwordx4 v5, s[20:23], s91 offen offset:0 lds
v_mul_f32 v241, v241, v155
v_exp_f32 v238, v238
v_exp_f32 v239, v239
s_waitcnt lgkmcnt(11)
v_mfma_f32_32x32x16_bf16 v[176:191], v[132:135], v[84:87], v[176:191]
buffer_load_dwordx4 v6, s[20:23], s91 offen offset:1024 lds
v_exp_f32 v240, v240
v_exp_f32 v241, v241
v_fma_f32 v238, v238, v235, v235
v_fma_f32 v239, v239, v235, v235
s_waitcnt lgkmcnt(7)
v_mfma_f32_32x32x16_bf16 v[176:191], v[136:139], v[88:91], v[176:191]
buffer_load_dwordx4 v5, s[20:23], s92 offen offset:2048 lds
v_fma_f32 v240, v240, v235, v235
s_waitcnt vmcnt(15)
v_cmp_ne_u32 vcc, s89, v215
s_nop 0
s_cmp_lg_u64 vcc, 0
s_cbranch_scc1 RCS1L
BCS1L:
v_fma_f32 v241, v241, v235, v235
v_mov_b32 v215, 0
v_rcp_f32 v238, v238
v_rcp_f32 v239, v239
s_waitcnt lgkmcnt(3)
v_mfma_f32_32x32x16_bf16 v[176:191], v[140:143], v[92:95], v[176:191]
buffer_load_dwordx4 v6, s[20:23], s92 offen offset:3072 lds
v_rcp_f32 v240, v240
v_rcp_f32 v241, v241
v_mul_f32 v238, v238, v152
s_waitcnt vmcnt(12)
s_barrier
v_mfma_f32_32x32x16_bf16 v[176:191], v[32:35], v[96:99], v[176:191]
s_add_u32 m0, s90, 0
s_add_u32 s91, s48, 14336
s_add_u32 s92, s49, 14336
ds_read_b64_tr_b16 v[128:129], v1 offset:32768
ds_read_b64_tr_b16 v[130:131], v1 offset:33792
buffer_load_dwordx4 v5, s[20:23], s91 offen offset:0 lds
v_mul_f32 v239, v239, v153
v_mul_f32 v240, v240, v154
v_mul_f32 v241, v241, v155
v_cvt_pk_bf16_f32 v152, v238, v239
v_cvt_pk_bf16_f32 v153, v240, v241
v_mfma_f32_32x32x16_bf16 v[176:191], v[36:39], v[100:103], v[176:191]
ds_read_b64_tr_b16 v[132:133], v1 offset:36864
ds_read_b64_tr_b16 v[134:135], v1 offset:37888
buffer_load_dwordx4 v6, s[20:23], s91 offen offset:1024 lds
v_mul_f32 v238, v156, v156
v_mfma_f32_32x32x16_bf16 v[176:191], v[212:215], v[208:211], v[176:191]
v_mul_f32 v239, v157, v157
v_mul_f32 v240, v158, v158
v_mul_f32 v241, v159, v159
v_fma_f32 v238, v238, v237, v234
v_mfma_f32_32x32x16_bf16 v[176:191], v[40:43], v[104:107], v[176:191]
ds_read_b64_tr_b16 v[136:137], v1 offset:40960
ds_read_b64_tr_b16 v[138:139], v1 offset:41984
buffer_load_dwordx4 v5, s[20:23], s92 offen offset:2048 lds
v_fma_f32 v239, v239, v237, v234
v_fma_f32 v240, v240, v237, v234
v_fma_f32 v241, v241, v237, v234
v_mul_f32 v238, v238, v156
v_mul_f32 v239, v239, v157
v_mul_f32 v240, v240, v158
s_waitcnt lgkmcnt(7)
v_mfma_f32_32x32x16_bf16 v[176:191], v[44:47], v[108:111], v[176:191]
ds_read_b64_tr_b16 v[140:141], v1 offset:45056
ds_read_b64_tr_b16 v[142:143], v1 offset:46080
buffer_load_dwordx4 v6, s[20:23], s92 offen offset:3072 lds
v_mul_f32 v241, v241, v159
v_exp_f32 v238, v238
v_exp_f32 v239, v239
s_waitcnt vmcnt(12) lgkmcnt(8)
s_barrier
s_waitcnt lgkmcnt(6)
v_mfma_f32_32x32x16_bf16 v[176:191], v[128:131], v[112:115], v[176:191]
s_add_u32 m0, s90, 16384
s_add_u32 s91, s50, 14336
s_add_u32 s92, s51, 14336
ds_read_b64_tr_b16 v[128:129], v1 offset:49152
ds_read_b64_tr_b16 v[130:131], v1 offset:50176
buffer_load_dwordx4 v5, s[20:23], s91 offen offset:0 lds
ds_read_b128 v[64:67], v3 offset:0
v_exp_f32 v240, v240
v_exp_f32 v241, v241
v_fma_f32 v238, v238, v235, v235
v_fma_f32 v239, v239, v235, v235
s_waitcnt lgkmcnt(7)
v_mfma_f32_32x32x16_bf16 v[176:191], v[132:135], v[116:119], v[176:191]
ds_read_b64_tr_b16 v[132:133], v1 offset:53248
ds_read_b64_tr_b16 v[134:135], v1 offset:54272
buffer_load_dwordx4 v6, s[20:23], s91 offen offset:1024 lds
ds_read_b128 v[68:71], v3 offset:1024
v_fma_f32 v240, v240, v235, v235
v_fma_f32 v241, v241, v235, v235
v_rcp_f32 v238, v238
v_rcp_f32 v239, v239
s_waitcnt lgkmcnt(8)
v_mfma_f32_32x32x16_bf16 v[176:191], v[136:139], v[120:123], v[176:191]
ds_read_b64_tr_b16 v[136:137], v1 offset:57344
ds_read_b64_tr_b16 v[138:139], v1 offset:58368
buffer_load_dwordx4 v5, s[20:23], s92 offen offset:2048 lds
ds_read_b128 v[72:75], v3 offset:2048
v_rcp_f32 v240, v240
v_rcp_f32 v241, v241
v_mul_f32 v238, v238, v156
s_waitcnt lgkmcnt(9)
v_mfma_f32_32x32x16_bf16 v[176:191], v[140:143], v[124:127], v[176:191]
ds_read_b64_tr_b16 v[140:141], v1 offset:61440
ds_read_b64_tr_b16 v[142:143], v1 offset:62464
buffer_load_dwordx4 v6, s[20:23], s92 offen offset:3072 lds
ds_read_b128 v[76:79], v3 offset:3072
v_mul_f32 v239, v239, v157
v_mul_f32 v240, v240, v158
v_mul_f32 v241, v241, v159
v_cvt_pk_bf16_f32 v154, v238, v239
v_cvt_pk_bf16_f32 v155, v240, v241
s_waitcnt vmcnt(8)
s_barrier
s_waitcnt lgkmcnt(9)
v_mfma_f32_32x32x16_bf16 v[192:207], v[64:67], v[128:131], 0
s_add_u32 m0, s90, 32768
s_add_u32 s91, s52, 14336
s_add_u32 s92, s53, 14336
ds_read_b64_tr_b16 v[128:129], v2 offset:0
ds_read_b64_tr_b16 v[130:131], v2 offset:1024
ds_read_b64_tr_b16 v[32:33], v2 offset:16384
ds_read_b64_tr_b16 v[34:35], v2 offset:17408
buffer_load_dwordx4 v5, s[20:23], s91 offen offset:0 lds
v_mul_f32 v238, v176, v176
v_lshlrev_b32 v216, 1, v247
v_mul_f32 v239, v177, v177
buffer_load_dwordx2 v[216:217], v216, s[32:35], s73 offen sc1
v_mul_f32 v240, v178, v178
v_mul_f32 v241, v179, v179
v_fma_f32 v238, v238, v237, v234
v_fma_f32 v239, v239, v237, v234
v_fma_f32 v240, v240, v237, v234
v_fma_f32 v241, v241, v237, v234
s_waitcnt lgkmcnt(10)
v_mfma_f32_32x32x16_bf16 v[192:207], v[68:71], v[132:135], v[192:207]
ds_read_b64_tr_b16 v[132:133], v2 offset:4096
ds_read_b64_tr_b16 v[134:135], v2 offset:5120
ds_read_b64_tr_b16 v[36:37], v2 offset:20480
ds_read_b64_tr_b16 v[38:39], v2 offset:21504
buffer_load_dwordx4 v6, s[20:23], s91 offen offset:1024 lds
v_mul_f32 v238, v238, v176
v_mul_f32 v239, v239, v177
v_mul_f32 v240, v240, v178
v_mul_f32 v241, v241, v179
v_exp_f32 v238, v238
v_exp_f32 v239, v239
s_waitcnt lgkmcnt(11)
v_mfma_f32_32x32x16_bf16 v[192:207], v[72:75], v[136:139], v[192:207]
ds_read_b64_tr_b16 v[136:137], v2 offset:8192
ds_read_b64_tr_b16 v[138:139], v2 offset:9216
ds_read_b64_tr_b16 v[40:41], v2 offset:24576
ds_read_b64_tr_b16 v[42:43], v2 offset:25600
buffer_load_dwordx4 v5, s[20:23], s92 offen offset:2048 lds
v_exp_f32 v240, v240
v_exp_f32 v241, v241
v_fma_f32 v238, v238, v235, v235
v_fma_f32 v239, v239, v235, v235
v_fma_f32 v240, v240, v235, v235
s_waitcnt lgkmcnt(12)
v_mfma_f32_32x32x16_bf16 v[192:207], v[76:79], v[140:143], v[192:207]
ds_read_b64_tr_b16 v[140:141], v2 offset:12288
ds_read_b64_tr_b16 v[142:143], v2 offset:13312
ds_read_b64_tr_b16 v[44:45], v2 offset:28672
ds_read_b64_tr_b16 v[46:47], v2 offset:29696
buffer_load_dwordx4 v6, s[20:23], s92 offen offset:3072 lds
v_fma_f32 v241, v241, v235, v235
v_lshrrev_b32 v245, 5, v0
v_rcp_f32 v238, v238
v_lshlrev_b32 v245, 6, v245
v_rcp_f32 v239, v239
v_lshl_add_u32 v245, s86, 7, v245
v_rcp_f32 v240, v240
ds_read_b128 v[48:51], v245 offset:0
ds_read_b128 v[52:55], v245 offset:16
ds_read_b128 v[56:59], v245 offset:32
ds_read_b128 v[60:63], v245 offset:48
s_barrier
s_waitcnt lgkmcnt(15)
v_mfma_f32_32x32x16_bf16 v[80:95], v[64:67], v[128:131], 0
s_add_u32 m0, s90, 49152
s_add_u32 s91, s48, 114688
s_add_u32 s92, s49, 114688
ds_write_b128 v4, v[152:155] offset:4096
buffer_load_dwordx4 v5, s[20:23], s91 offen offset:0 lds
v_rcp_f32 v241, v241
v_mul_f32 v238, v238, v176
v_mul_f32 v239, v239, v177
v_mul_f32 v240, v240, v178
v_mul_f32 v241, v241, v179
v_cvt_pk_bf16_f32 v176, v238, v239
v_cvt_pk_bf16_f32 v177, v240, v241
s_waitcnt lgkmcnt(15)
v_mfma_f32_32x32x16_bf16 v[80:95], v[68:71], v[132:135], v[80:95]
buffer_load_dwordx4 v6, s[20:23], s91 offen offset:1024 lds
v_mul_f32 v238, v180, v180
v_mul_f32 v239, v181, v181
v_mul_f32 v240, v182, v182
v_mul_f32 v241, v183, v183
v_fma_f32 v238, v238, v237, v234
v_fma_f32 v239, v239, v237, v234
v_fma_f32 v240, v240, v237, v234
v_fma_f32 v241, v241, v237, v234
s_waitcnt lgkmcnt(11)
v_mfma_f32_32x32x16_bf16 v[80:95], v[72:75], v[136:139], v[80:95]
buffer_load_dwordx4 v5, s[20:23], s92 offen offset:2048 lds
v_mul_f32 v238, v238, v180
v_mul_f32 v239, v239, v181
v_mul_f32 v240, v240, v182
v_mul_f32 v241, v241, v183
v_exp_f32 v238, v238
v_exp_f32 v239, v239
s_waitcnt lgkmcnt(7)
v_mfma_f32_32x32x16_bf16 v[80:95], v[76:79], v[140:143], v[80:95]
buffer_load_dwordx4 v6, s[20:23], s92 offen offset:3072 lds
v_exp_f32 v240, v240
v_add_u32 v8, 6144, v8
v_exp_f32 v241, v241
v_fma_f32 v238, v238, v235, v235
v_fma_f32 v239, v239, v235, v235
v_fma_f32 v240, v240, v235, v235
s_waitcnt vmcnt(9) lgkmcnt(0)
s_barrier
v_mfma_f32_32x32x16_bf16 v[112:127], v[64:67], v[32:35], 0
s_add_u32 m0, s90, 65536
s_add_u32 s92, s55, 12288
ds_read_b64_tr_b16 v[128:129], v1 offset:0
ds_read_b64_tr_b16 v[130:131], v1 offset:1024
ds_read_b64_tr_b16 v[32:33], v1 offset:16384
ds_read_b64_tr_b16 v[34:35], v1 offset:17408
buffer_load_dwordx4 v7, s[24:27], s55 offen offset:0 lds
ds_read_b128 v[96:99], v3 offset:4096
v_fma_f32 v241, v241, v235, v235
v_rcp_f32 v238, v238
v_rcp_f32 v239, v239
v_rcp_f32 v240, v240
v_mfma_f32_32x32x16_bf16 v[112:127], v[68:71], v[36:39], v[112:127]
ds_read_b64_tr_b16 v[132:133], v1 offset:4096
ds_read_b64_tr_b16 v[134:135], v1 offset:5120
ds_read_b64_tr_b16 v[36:37], v1 offset:20480
ds_read_b64_tr_b16 v[38:39], v1 offset:21504
buffer_load_dwordx4 v8, s[24:27], s55 offen offset:1024 lds
ds_read_b128 v[100:103], v3 offset:5120
v_rcp_f32 v241, v241
v_mul_f32 v238, v238, v180
v_mul_f32 v239, v239, v181
v_mul_f32 v240, v240, v182
v_mul_f32 v241, v241, v183
v_cvt_pk_bf16_f32 v178, v238, v239
v_cvt_pk_bf16_f32 v179, v240, v241
v_mfma_f32_32x32x16_bf16 v[112:127], v[72:75], v[40:43], v[112:127]
ds_read_b64_tr_b16 v[136:137], v1 offset:8192
ds_read_b64_tr_b16 v[138:139], v1 offset:9216
ds_read_b64_tr_b16 v[40:41], v1 offset:24576
ds_read_b64_tr_b16 v[42:43], v1 offset:25600
buffer_load_dwordx4 v7, s[24:27], s92 offen offset:2048 lds
ds_read_b128 v[104:107], v3 offset:6144
s_waitcnt vmcnt(10)
v_cmp_ne_u32 vcc, s89, v217
s_nop 0
s_cmp_lg_u64 vcc, 0
s_cbranch_scc1 RKL
BKL:
v_fma_f32 v244, v224, v216, v243
s_nop 1
v_fmac_f32_dpp v244, v216, v225 row_ror:8 row_mask:0xf bank_mask:0xf
v_fma_f32 v243, v11, v244, v242
s_nop 1
v_fmac_f32_dpp v243, v244, v12 row_ror:8 row_mask:0xf bank_mask:0xf
v_fma_f32 v160, v9, v244, v160
v_mfma_f32_32x32x16_bf16 v[112:127], v[76:79], v[44:47], v[112:127]
ds_read_b64_tr_b16 v[140:141], v1 offset:12288
ds_read_b64_tr_b16 v[142:143], v1 offset:13312
ds_read_b64_tr_b16 v[44:45], v1 offset:28672
ds_read_b64_tr_b16 v[46:47], v1 offset:29696
buffer_load_dwordx4 v8, s[24:27], s92 offen offset:3072 lds
ds_read_b128 v[108:111], v3 offset:7168
v_fma_f32 v168, v9, v243, v168
v_fmac_f32_dpp v160, v244, v10 row_ror:8 row_mask:0xf bank_mask:0xf
s_nop 0
v_fmac_f32_dpp v168, v243, v10 row_ror:8 row_mask:0xf bank_mask:0xf
v_fma_f32 v161, v9, v160, v161
v_fma_f32 v169, v9, v168, v169
s_nop 0
v_fmac_f32_dpp v161, v160, v10 row_ror:8 row_mask:0xf bank_mask:0xf
v_fmac_f32_dpp v169, v168, v10 row_ror:8 row_mask:0xf bank_mask:0xf
s_barrier
s_waitcnt lgkmcnt(15)
v_mfma_f32_32x32x16_bf16 v[192:207], v[96:99], v[128:131], v[192:207]
s_add_u32 m0, s90, 81920
s_add_u32 s92, s55, 12288
ds_write_b128 v4, v[176:179] offset:16384
buffer_load_dwordx4 v7, s[28:31], s55 offen offset:0 lds
v_fma_f32 v162, v9, v161, v162
v_fma_f32 v170, v9, v169, v170
s_nop 0
v_fmac_f32_dpp v162, v161, v10 row_ror:8 row_mask:0xf bank_mask:0xf
v_fmac_f32_dpp v170, v169, v10 row_ror:8 row_mask:0xf bank_mask:0xf
v_fma_f32 v163, v9, v162, v163
v_fma_f32 v171, v9, v170, v171
s_nop 0
v_fmac_f32_dpp v163, v162, v10 row_ror:8 row_mask:0xf bank_mask:0xf
s_waitcnt lgkmcnt(11)
v_mfma_f32_32x32x16_bf16 v[192:207], v[100:103], v[132:135], v[192:207]
buffer_load_dwordx4 v8, s[28:31], s55 offen offset:1024 lds
v_fmac_f32_dpp v171, v170, v10 row_ror:8 row_mask:0xf bank_mask:0xf
v_fma_f32 v164, v9, v163, v164
v_fma_f32 v172, v9, v171, v172
s_nop 0
v_fmac_f32_dpp v164, v163, v10 row_ror:8 row_mask:0xf bank_mask:0xf
v_fmac_f32_dpp v172, v171, v10 row_ror:8 row_mask:0xf bank_mask:0xf
v_mul_f32 v48, v160, v48
v_mul_f32 v49, v161, v49
s_waitcnt lgkmcnt(6)
v_mfma_f32_32x32x16_bf16 v[192:207], v[104:107], v[136:139], v[192:207]
buffer_load_dwordx4 v7, s[28:31], s92 offen offset:2048 lds
v_mul_f32 v50, v162, v50
v_mul_f32 v51, v163, v51
v_cvt_pk_bf16_f32 v48, v48, v49
v_cvt_pk_bf16_f32 v49, v50, v51
v_mul_f32 v56, v168, v56
v_mul_f32 v57, v169, v57
v_mul_f32 v58, v170, v58
s_waitcnt lgkmcnt(1)
v_mfma_f32_32x32x16_bf16 v[192:207], v[108:111], v[140:143], v[192:207]
buffer_load_dwordx4 v8, s[28:31], s92 offen offset:3072 lds
v_mul_f32 v59, v171, v59
v_cvt_pk_bf16_f32 v56, v56, v57
v_cvt_pk_bf16_f32 v57, v58, v59
v_fma_f32 v165, v9, v164, v165
v_fma_f32 v173, v9, v172, v173
s_nop 0
v_fmac_f32_dpp v165, v164, v10 row_ror:8 row_mask:0xf bank_mask:0xf
s_waitcnt vmcnt(8) lgkmcnt(0)
s_barrier
v_mfma_f32_32x32x16_bf16 v[80:95], v[96:99], v[32:35], v[80:95]
s_add_u32 m0, s90, 0
s_add_u32 s91, s48, 129024
s_add_u32 s92, s49, 129024
ds_read_b64_tr_b16 v[128:129], v1 offset:32768
ds_read_b64_tr_b16 v[130:131], v1 offset:33792
ds_read_b64_tr_b16 v[32:33], v1 offset:49152
ds_read_b64_tr_b16 v[34:35], v1 offset:50176
buffer_load_dwordx4 v5, s[20:23], s91 offen offset:0 lds
ds_read_b128 v[144:147], v3 offset:16384
v_fmac_f32_dpp v173, v172, v10 row_ror:8 row_mask:0xf bank_mask:0xf
v_fma_f32 v166, v9, v165, v166
v_fma_f32 v174, v9, v173, v174
s_nop 0
v_fmac_f32_dpp v166, v165, v10 row_ror:8 row_mask:0xf bank_mask:0xf
v_fmac_f32_dpp v174, v173, v10 row_ror:8 row_mask:0xf bank_mask:0xf
v_fma_f32 v167, v9, v166, v167
v_fma_f32 v175, v9, v174, v175
v_mfma_f32_32x32x16_bf16 v[80:95], v[100:103], v[36:39], v[80:95]
ds_read_b64_tr_b16 v[132:133], v1 offset:36864
ds_read_b64_tr_b16 v[134:135], v1 offset:37888
ds_read_b64_tr_b16 v[36:37], v1 offset:53248
ds_read_b64_tr_b16 v[38:39], v1 offset:54272
buffer_load_dwordx4 v6, s[20:23], s91 offen offset:1024 lds
ds_read_b128 v[148:151], v3 offset:17408
v_fmac_f32_dpp v167, v166, v10 row_ror:8 row_mask:0xf bank_mask:0xf
v_fmac_f32_dpp v175, v174, v10 row_ror:8 row_mask:0xf bank_mask:0xf
v_mul_f32 v52, v164, v52
v_mul_f32 v53, v165, v53
v_mul_f32 v54, v166, v54
v_mul_f32 v55, v167, v55
v_cvt_pk_bf16_f32 v50, v52, v53
v_mfma_f32_32x32x16_bf16 v[80:95], v[104:107], v[40:43], v[80:95]
ds_read_b64_tr_b16 v[136:137], v1 offset:40960
ds_read_b64_tr_b16 v[138:139], v1 offset:41984
ds_read_b64_tr_b16 v[40:41], v1 offset:57344
ds_read_b64_tr_b16 v[42:43], v1 offset:58368
buffer_load_dwordx4 v5, s[20:23], s92 offen offset:2048 lds
ds_read_b128 v[152:155], v3 offset:18432
v_cvt_pk_bf16_f32 v51, v54, v55
v_mul_f32 v60, v172, v60
v_mul_f32 v61, v173, v61
v_mul_f32 v62, v174, v62
v_mul_f32 v63, v175, v63
v_cvt_pk_bf16_f32 v58, v60, v61
v_cvt_pk_bf16_f32 v59, v62, v63
v_mfma_f32_32x32x16_bf16 v[80:95], v[108:111], v[44:47], v[80:95]
ds_read_b64_tr_b16 v[140:141], v1 offset:45056
ds_read_b64_tr_b16 v[142:143], v1 offset:46080
ds_read_b64_tr_b16 v[44:45], v1 offset:61440
ds_read_b64_tr_b16 v[46:47], v1 offset:62464
buffer_load_dwordx4 v6, s[20:23], s92 offen offset:3072 lds
ds_read_b128 v[156:159], v3 offset:19456
v_mul_f32 v238, v184, v184
v_mul_f32 v239, v185, v185
v_mul_f32 v240, v186, v186
v_mul_f32 v241, v187, v187
v_fma_f32 v238, v238, v237, v234
v_fma_f32 v239, v239, v237, v234
v_fma_f32 v240, v240, v237, v234
v_fma_f32 v241, v241, v237, v234
s_barrier
s_waitcnt lgkmcnt(15)
v_mfma_f32_32x32x16_bf16 v[112:127], v[96:99], v[128:131], v[112:127]
s_add_u32 m0, s90, 16384
s_add_u32 s91, s50, 114688
s_add_u32 s92, s51, 114688
ds_write_b128 v218, v[48:51]
buffer_load_dwordx4 v5, s[20:23], s91 offen offset:0 lds
v_mul_f32 v238, v238, v184
v_mul_f32 v239, v239, v185
v_mul_f32 v240, v240, v186
v_mul_f32 v241, v241, v187
v_exp_f32 v238, v238
v_exp_f32 v239, v239
PADL2:
s_cbranch_execz HOPB
s_waitcnt lgkmcnt(14)
v_mfma_f32_32x32x16_bf16 v[112:127], v[100:103], v[132:135], v[112:127]
v_xor_b32 v218, 32, v218
ds_write_b128 v218, v[56:59]
buffer_load_dwordx4 v6, s[20:23], s91 offen offset:1024 lds
v_exp_f32 v240, v240
v_exp_f32 v241, v241
v_fma_f32 v238, v238, v235, v235
v_fma_f32 v239, v239, v235, v235
v_fma_f32 v240, v240, v235, v235
v_fma_f32 v241, v241, v235, v235
v_rcp_f32 v238, v238
s_waitcnt lgkmcnt(10)
v_mfma_f32_32x32x16_bf16 v[112:127], v[104:107], v[136:139], v[112:127]
buffer_load_dwordx4 v5, s[20:23], s92 offen offset:2048 lds
v_rcp_f32 v239, v239
v_rcp_f32 v240, v240
v_rcp_f32 v241, v241
v_mul_f32 v238, v238, v184
v_mul_f32 v239, v239, v185
s_waitcnt lgkmcnt(5)
v_mfma_f32_32x32x16_bf16 v[112:127], v[108:111], v[140:143], v[112:127]
buffer_load_dwordx4 v6, s[20:23], s92 offen offset:3072 lds
v_mul_f32 v240, v240, v186
v_mul_f32 v241, v241, v187
v_cvt_pk_bf16_f32 v184, v238, v239
v_cvt_pk_bf16_f32 v185, v240, v241
v_mul_f32 v238, v188, v188
v_mul_f32 v239, v189, v189
v_mul_f32 v240, v190, v190
v_mul_f32 v241, v191, v191
s_waitcnt vmcnt(8) lgkmcnt(0)
s_barrier
v_mfma_f32_32x32x16_bf16 v[192:207], v[144:147], v[32:35], v[192:207]
s_add_u32 m0, s90, 32768
s_add_u32 s92, s56, 12288
ds_read_b128 v[128:131], v252 offset:0
ds_read_b128 v[48:51], v252 offset:16384
buffer_load_dwordx4 v7, s[24:27], s56 offen offset:0 lds
v_fma_f32 v238, v238, v237, v234
ds_read_b64_tr_b16 v[16:17], v219 offset:0
ds_read_b64_tr_b16 v[32:33], v219 offset:4096
v_fma_f32 v239, v239, v237, v234
ds_read_b64_tr_b16 v[18:19], v220 offset:0
ds_read_b64_tr_b16 v[34:35], v220 offset:4096
v_fma_f32 v240, v240, v237, v234
v_fma_f32 v241, v241, v237, v234
v_mul_f32 v238, v238, v188
v_mul_f32 v239, v239, v189
v_mul_f32 v240, v240, v190
v_mul_f32 v241, v241, v191
v_mfma_f32_32x32x16_bf16 v[192:207], v[148:151], v[36:39], v[192:207]
ds_read_b128 v[132:135], v253 offset:0
ds_read_b128 v[52:55], v253 offset:16384
buffer_load_dwordx4 v8, s[24:27], s56 offen offset:1024 lds
v_exp_f32 v238, v238
ds_read_b64_tr_b16 v[20:21], v219 offset:1024
ds_read_b64_tr_b16 v[36:37], v219 offset:5120
v_exp_f32 v239, v239
ds_read_b64_tr_b16 v[22:23], v220 offset:1024
ds_read_b64_tr_b16 v[38:39], v220 offset:5120
v_exp_f32 v240, v240
v_exp_f32 v241, v241
v_fma_f32 v238, v238, v235, v235
v_mfma_f32_32x32x16_bf16 v[192:207], v[152:155], v[40:43], v[192:207]
ds_read_b128 v[136:139], v254 offset:0
ds_read_b128 v[56:59], v254 offset:16384
buffer_load_dwordx4 v7, s[24:27], s92 offen offset:2048 lds
v_fma_f32 v239, v239, v235, v235
ds_read_b64_tr_b16 v[24:25], v219 offset:2048
ds_read_b64_tr_b16 v[40:41], v219 offset:6144
v_fma_f32 v240, v240, v235, v235
ds_read_b64_tr_b16 v[26:27], v220 offset:2048
ds_read_b64_tr_b16 v[42:43], v220 offset:6144
v_fma_f32 v241, v241, v235, v235
v_rcp_f32 v238, v238
v_rcp_f32 v239, v239
v_rcp_f32 v240, v240
v_mfma_f32_32x32x16_bf16 v[192:207], v[156:159], v[44:47], v[192:207]
ds_read_b128 v[140:143], v255 offset:0
ds_read_b128 v[60:63], v255 offset:16384
buffer_load_dwordx4 v8, s[24:27], s92 offen offset:3072 lds
v_rcp_f32 v241, v241
ds_read_b64_tr_b16 v[28:29], v219 offset:3072
ds_read_b64_tr_b16 v[44:45], v219 offset:7168
v_mul_f32 v238, v238, v188
ds_read_b64_tr_b16 v[30:31], v220 offset:3072
ds_read_b64_tr_b16 v[46:47], v220 offset:7168
v_mul_f32 v239, v239, v189
v_mul_f32 v240, v240, v190
v_mul_f32 v241, v241, v191
v_cvt_pk_bf16_f32 v186, v238, v239
v_cvt_pk_bf16_f32 v187, v240, v241
s_barrier
s_waitcnt lgkmcnt(15)
v_mfma_f32_32x32x16_bf16 v[192:207], v[16:19], v[128:131], v[192:207]
s_add_u32 m0, s90, 49152
s_add_u32 s92, s56, 12288
ds_write_b128 v4, v[184:187] offset:20480
buffer_load_dwordx4 v7, s[28:31], s56 offen offset:0 lds
s_lshr_b32 s94, s85, 1
s_and_b32 s95, s85, 1
v_lshrrev_b32 v216, 5, v0
v_and_b32 v11, 31, v0
v_lshl_add_u32 v216, v216, 1, s94
s_waitcnt lgkmcnt(14)
v_mfma_f32_32x32x16_bf16 v[192:207], v[20:23], v[132:135], v[192:207]
buffer_load_dwordx4 v8, s[28:31], s56 offen offset:1024 lds
v_lshl_add_u32 v11, s95, 5, v11
v_lshl_add_u32 v14, s94, 10, v221
v_lshl_add_u32 v11, s88, 6, v11
s_movk_i32 s95, 7168
v_lshlrev_b32 v11, 1, v11
s_waitcnt lgkmcnt(8)
v_mfma_f32_32x32x16_bf16 v[192:207], v[24:27], v[136:139], v[192:207]
buffer_load_dwordx4 v7, s[28:31], s92 offen offset:2048 lds
v_mad_u32_u24 v13, v216, s95, v11
v_lshlrev_b32 v216, 5, v216
v_lshlrev_b32 v13, 1, v13
v_lshl_add_u32 v216, s86, 7, v216
s_waitcnt lgkmcnt(2)
v_mfma_f32_32x32x16_bf16 v[192:207], v[28:31], v[140:143], v[192:207]
buffer_load_dwordx4 v8, s[28:31], s92 offen offset:3072 lds
global_load_ushort v12, v11, s[46:47]
global_load_ushort v11, v11, s[42:43]
s_waitcnt vmcnt(14) lgkmcnt(0)
s_barrier
v_mfma_f32_32x32x16_bf16 v[192:207], v[32:35], v[48:51], v[192:207]
s_add_u32 m0, s90, 65536
s_add_u32 s91, s50, 129024
s_add_u32 s92, s51, 129024
ds_read_b64_tr_b16 v[128:129], v1 offset:0
ds_read_b64_tr_b16 v[130:131], v1 offset:1024
buffer_load_dwordx4 v5, s[20:23], s91 offen offset:0 lds
ds_read_b128 v[64:67], v3 offset:20480
s_mul_i32 s60, s87, 42
v_lshrrev_b32 v222, 4, v221
s_lshr_b32 s94, s85, 1
v_lshrrev_b32 v208, 4, v0
v_mfma_f32_32x32x16_bf16 v[192:207], v[36:39], v[52:55], v[192:207]
ds_read_b64_tr_b16 v[132:133], v1 offset:4096
ds_read_b64_tr_b16 v[134:135], v1 offset:5120
buffer_load_dwordx4 v6, s[20:23], s91 offen offset:1024 lds
ds_read_b128 v[68:71], v3 offset:21504
s_add_u32 s60, s60, s94
v_and_b32 v222, 0x180, v222
s_mul_i32 s60, s60, 8704
v_mfma_f32_32x32x16_bf16 v[192:207], v[40:43], v[56:59], v[192:207]
ds_read_b64_tr_b16 v[136:137], v1 offset:8192
ds_read_b64_tr_b16 v[138:139], v1 offset:9216
buffer_load_dwordx4 v5, s[20:23], s92 offen offset:2048 lds
ds_read_b128 v[72:75], v3 offset:22528
v_and_b32 v215, 3, v0
s_and_b32 s71, s2, 7
v_lshl_add_u32 v222, v208, 4, v222
v_mfma_f32_32x32x16_bf16 v[192:207], v[44:47], v[60:63], v[192:207]
ds_read_b64_tr_b16 v[140:141], v1 offset:12288
ds_read_b64_tr_b16 v[142:143], v1 offset:13312
buffer_load_dwordx4 v6, s[20:23], s92 offen offset:3072 lds
ds_read_b128 v[76:79], v3 offset:23552
s_mul_i32 s71, s71, 52224
v_and_b32 v208, 4, v0
s_add_u32 s60, s60, 1048576
v_lshl_add_u32 v222, v215, 2, v222
s_waitcnt vmcnt(14)
s_barrier
s_waitcnt lgkmcnt(9)
v_mfma_f32_32x32x16_bf16 v[192:207], v[64:67], v[128:131], v[192:207]
s_add_u32 m0, s90, 81920
s_add_u32 s91, s52, 114688
s_add_u32 s92, s53, 114688
ds_read_b64_tr_b16 v[128:129], v1 offset:16384
ds_read_b64_tr_b16 v[130:131], v1 offset:17408
buffer_load_dwordx4 v5, s[20:23], s91 offen offset:0 lds
s_add_u32 s59, s60, s71
v_mul_u32_u24 v215, 2176, v208
s_mul_i32 s99, s37, 52224
s_waitcnt lgkmcnt(8)
v_mfma_f32_32x32x16_bf16 v[192:207], v[68:71], v[132:135], v[192:207]
ds_read_b64_tr_b16 v[132:133], v1 offset:20480
ds_read_b64_tr_b16 v[134:135], v1 offset:21504
buffer_load_dwordx4 v6, s[20:23], s91 offen offset:1024 lds
v_add_u32 v222, 8192, v222
s_add_u32 s99, s99, s60
v_lshl_add_u32 v208, v208, 4, v222
s_waitcnt lgkmcnt(7)
v_mfma_f32_32x32x16_bf16 v[192:207], v[72:75], v[136:139], v[192:207]
ds_read_b64_tr_b16 v[136:137], v1 offset:24576
ds_read_b64_tr_b16 v[138:139], v1 offset:25600
buffer_load_dwordx4 v5, s[20:23], s92 offen offset:2048 lds
s_bfe_u32 s71, s2, 0x30008
v_add_u32 v222, v215, v222
s_mul_i32 s71, s71, 52224
v_bfe_u32 v215, v0, 3, 1
s_waitcnt lgkmcnt(6)
v_mfma_f32_32x32x16_bf16 v[192:207], v[76:79], v[140:143], v[192:207]
ds_read_b64_tr_b16 v[140:141], v1 offset:28672
ds_read_b64_tr_b16 v[142:143], v1 offset:29696
buffer_load_dwordx4 v6, s[20:23], s92 offen offset:3072 lds
s_add_u32 s60, s60, 17408
v_lshl_add_u32 v208, v215, 31, v208
s_add_u32 s60, s60, s71
s_add_u32 s99, s99, 34816
s_waitcnt vmcnt(14)
s_barrier
s_waitcnt lgkmcnt(6)
v_mfma_f32_32x32x16_bf16 v[80:95], v[144:147], v[128:131], v[80:95]
s_add_u32 m0, s90, 0
s_add_u32 s92, s57, 12288
ds_read_b128 v[128:131], v248 offset:32768
buffer_load_dwordx4 v7, s[24:27], s57 offen offset:0 lds
s_waitcnt lgkmcnt(5)
v_mfma_f32_32x32x16_bf16 v[80:95], v[148:151], v[132:135], v[80:95]
ds_read_b128 v[132:135], v249 offset:32768
buffer_load_dwordx4 v8, s[24:27], s57 offen offset:1024 lds
v_cvt_pk_bf16_f32 v192, v192, v193
v_cvt_pk_bf16_f32 v193, v194, v195
v_cvt_pk_bf16_f32 v194, v196, v197
v_cvt_pk_bf16_f32 v195, v198, v199
v_cvt_pk_bf16_f32 v196, v200, v201
s_waitcnt lgkmcnt(4)
v_mfma_f32_32x32x16_bf16 v[80:95], v[152:155], v[136:139], v[80:95]
ds_read_b128 v[136:139], v250 offset:32768
buffer_load_dwordx4 v7, s[24:27], s92 offen offset:2048 lds
v_add3_u32 v212, v192, v193, v194
v_cvt_pk_bf16_f32 v197, v202, v203
v_add3_u32 v212, v212, v195, s89
v_cvt_pk_bf16_f32 v198, v204, v205
v_cvt_pk_bf16_f32 v199, v206, v207
buffer_store_dwordx4 v[192:195], v221, s[32:35], s59 offen offset:0 sc1
s_waitcnt lgkmcnt(3)
v_mfma_f32_32x32x16_bf16 v[80:95], v[156:159], v[140:143], v[80:95]
ds_read_b128 v[140:143], v251 offset:32768
buffer_load_dwordx4 v8, s[24:27], s92 offen offset:3072 lds
v_add3_u32 v213, v196, v197, v198
v_add_u32_dpp v212, v212, v212 row_ror:4 row_mask:0xf bank_mask:0x5
v_add3_u32 v213, v213, v199, s89
s_nop 1
v_add_u32_dpp v212, v213, v213 row_ror:4 row_mask:0xf bank_mask:0xa
s_nop 1
v_add_u32_dpp v212, v212, v212 row_ror:8 row_mask:0xf bank_mask:0xf
buffer_store_dwordx4 v[196:199], v221, s[32:35], s59 offen offset:1024 sc1
buffer_store_dword v212, v208, s[32:35], s59 offen sc1
s_waitcnt vmcnt(17)
s_barrier
s_waitcnt lgkmcnt(3)
v_mfma_f32_32x32x16_bf16 v[80:95], v[16:19], v[128:131], v[80:95]
s_add_u32 m0, s90, 16384
s_add_u32 s92, s57, 12288
ds_read_b128 v[128:131], v248 offset:49152
buffer_load_dwordx4 v7, s[28:31], s57 offen offset:0 lds
s_lshl_b32 s71, s87, 1
ds_read_b128 v[176:179], v216 offset:0
v_lshlrev_b32 v160, 16, v230
v_lshrrev_b32 v214, 3, v0
ds_read_b128 v[180:183], v216 offset:16
v_and_b32 v161, 0xffff0000, v230
v_lshlrev_b32 v162, 16, v231
v_and_b32 v163, 0xffff0000, v231
s_waitcnt lgkmcnt(5)
v_mfma_f32_32x32x16_bf16 v[80:95], v[20:23], v[132:135], v[80:95]
ds_read_b128 v[132:135], v249 offset:49152
buffer_load_dwordx4 v8, s[28:31], s57 offen offset:1024 lds
s_add_u32 s71, s71, s86
v_lshlrev_b32 v164, 16, v232
v_and_b32 v165, 0xffff0000, v232
v_lshlrev_b32 v166, 16, v233
s_waitcnt lgkmcnt(5)
v_mfma_f32_32x32x16_bf16 v[80:95], v[24:27], v[136:139], v[80:95]
ds_read_b128 v[136:139], v250 offset:49152
buffer_load_dwordx4 v7, s[28:31], s92 offen offset:2048 lds
v_and_b32 v215, 7, v0
v_and_b32 v167, 0xffff0000, v233
s_mul_i32 s38, s71, 57344
s_waitcnt vmcnt(19)
v_lshlrev_b32 v12, 16, v12
s_waitcnt vmcnt(18)
v_lshlrev_b32 v11, 16, v11
v_fma_f32 v160, v160, v11, -v12
s_waitcnt lgkmcnt(5)
v_mfma_f32_32x32x16_bf16 v[80:95], v[28:31], v[140:143], v[80:95]
ds_read_b128 v[140:143], v251 offset:49152
buffer_load_dwordx4 v8, s[28:31], s92 offen offset:3072 lds
v_mul_u32_u24 v214, 1792, v214
v_fma_f32 v161, v161, v11, -v12
v_fma_f32 v162, v162, v11, -v12
v_fma_f32 v163, v163, v11, -v12
v_fma_f32 v164, v164, v11, -v12
s_waitcnt vmcnt(15)
s_barrier
s_waitcnt lgkmcnt(5)
v_mfma_f32_32x32x16_bf16 v[80:95], v[32:35], v[128:131], v[80:95]
s_add_u32 m0, s90, 32768
s_add_u32 s91, s52, 129024
s_add_u32 s92, s53, 129024
ds_read_b64_tr_b16 v[128:129], v2 offset:0
ds_read_b64_tr_b16 v[130:131], v2 offset:1024
buffer_load_dwordx4 v5, s[20:23], s91 offen offset:0 lds
s_lshr_b32 s94, s85, 1
v_fma_f32 v165, v165, v11, -v12
v_lshl_add_u32 v214, v215, 4, v214
v_fma_f32 v166, v166, v11, -v12
v_fma_f32 v167, v167, v11, -v12
s_waitcnt lgkmcnt(6)
v_fma_f32 v160, v160, v176, v12
s_waitcnt lgkmcnt(4)
v_mfma_f32_32x32x16_bf16 v[80:95], v[36:39], v[132:135], v[80:95]
ds_read_b64_tr_b16 v[132:133], v2 offset:4096
ds_read_b64_tr_b16 v[134:135], v2 offset:5120
buffer_load_dwordx4 v6, s[20:23], s91 offen offset:1024 lds
s_mul_i32 s71, s94, 28672
v_fma_f32 v161, v161, v177, v12
s_add_u32 s61, s38, s71
v_fma_f32 v162, v162, v178, v12
v_fma_f32 v163, v163, v179, v12
s_waitcnt lgkmcnt(5)
v_mfma_f32_32x32x16_bf16 v[80:95], v[40:43], v[136:139], v[80:95]
ds_read_b64_tr_b16 v[136:137], v2 offset:8192
ds_read_b64_tr_b16 v[138:139], v2 offset:9216
buffer_load_dwordx4 v5, s[20:23], s92 offen offset:2048 lds
s_lshl_b32 s71, s37, 1
v_fma_f32 v164, v164, v180, v12
s_and_b32 s95, s85, 1
v_fma_f32 v165, v165, v181, v12
s_add_u32 s71, s71, s95
v_fma_f32 v166, v166, v182, v12
v_fma_f32 v167, v167, v183, v12
s_waitcnt lgkmcnt(6)
v_mfma_f32_32x32x16_bf16 v[80:95], v[44:47], v[140:143], v[80:95]
ds_read_b64_tr_b16 v[140:141], v2 offset:12288
ds_read_b64_tr_b16 v[142:143], v2 offset:13312
buffer_load_dwordx4 v6, s[20:23], s92 offen offset:3072 lds
s_lshl_b32 s71, s71, 7
v_mov_b64 v[168:169], 0
s_add_u32 s61, s61, s71
v_mov_b64 v[170:171], 0
s_mov_b32 s78, 3670016
v_mov_b64 v[172:173], 0
s_mov_b32 s79, 0x20000
v_mov_b64 v[174:175], 0
s_waitcnt vmcnt(15)
s_barrier
s_waitcnt lgkmcnt(6)
v_mfma_f32_32x32x16_bf16 v[80:95], v[64:67], v[128:131], v[80:95]
s_add_u32 m0, s90, 49152
s_add_u32 s91, s54, 0
s_add_u32 s92, s54, 112640
ds_read_b64_tr_b16 v[128:129], v2 offset:16384
ds_read_b64_tr_b16 v[130:131], v2 offset:17408
buffer_load_dwordx4 v5, s[20:23], s91 offen offset:0 lds
s_mul_i32 s71, s87, 7
s_add_u32 s71, s71, s88
s_mul_i32 s71, s71, 52224
s_add_u32 s8, s71, 1048576
s_add_u32 s9, s8, 8704
s_waitcnt lgkmcnt(6)
v_mfma_f32_32x32x16_bf16 v[80:95], v[68:71], v[132:135], v[80:95]
ds_read_b64_tr_b16 v[132:133], v2 offset:20480
ds_read_b64_tr_b16 v[134:135], v2 offset:21504
buffer_load_dwordx4 v6, s[20:23], s91 offen offset:1024 lds
s_add_u32 s10, s8, 17408
s_add_u32 s11, s8, 26112
s_add_u32 s44, s8, 34816
s_lshl_b32 s98, s89, 1
s_lshr_b32 s94, s85, 1
s_mul_i32 s71, s94, 14336
s_waitcnt lgkmcnt(6)
v_mfma_f32_32x32x16_bf16 v[80:95], v[72:75], v[136:139], v[80:95]
ds_read_b64_tr_b16 v[136:137], v2 offset:24576
ds_read_b64_tr_b16 v[138:139], v2 offset:25600
buffer_load_dwordx4 v5, s[20:23], s92 offen offset:2048 lds
s_add_u32 s12, s38, s71
s_lshl_b32 s71, s88, 1
s_and_b32 s95, s85, 1
s_add_u32 s71, s71, s95
s_lshl_b32 s71, s71, 7
s_waitcnt lgkmcnt(6)
v_mfma_f32_32x32x16_bf16 v[80:95], v[76:79], v[140:143], v[80:95]
ds_read_b64_tr_b16 v[140:141], v2 offset:28672
ds_read_b64_tr_b16 v[142:143], v2 offset:29696
buffer_load_dwordx4 v6, s[20:23], s92 offen offset:3072 lds
s_add_u32 s12, s12, s71
s_add_u32 s13, s12, 28672
v_lshl_add_u32 v222, s94, 6, v222
s_waitcnt vmcnt(14)
s_barrier
s_waitcnt lgkmcnt(6)
v_mfma_f32_32x32x16_bf16 v[112:127], v[144:147], v[128:131], v[112:127]
ds_read_b128 v[128:131], v248 offset:0
s_waitcnt lgkmcnt(5)
v_mfma_f32_32x32x16_bf16 v[112:127], v[148:151], v[132:135], v[112:127]
ds_read_b128 v[132:135], v249 offset:0
v_cvt_pk_bf16_f32 v80, v80, v81
v_cvt_pk_bf16_f32 v81, v82, v83
v_cvt_pk_bf16_f32 v82, v84, v85
v_cvt_pk_bf16_f32 v83, v86, v87
v_cvt_pk_bf16_f32 v84, v88, v89
s_waitcnt lgkmcnt(4)
v_mfma_f32_32x32x16_bf16 v[112:127], v[152:155], v[136:139], v[112:127]
ds_read_b128 v[136:139], v250 offset:0
v_add3_u32 v212, v80, v81, v82
v_cvt_pk_bf16_f32 v85, v90, v91
v_add3_u32 v212, v212, v83, s89
v_cvt_pk_bf16_f32 v86, v92, v93
v_cvt_pk_bf16_f32 v87, v94, v95
buffer_store_dwordx4 v[80:83], v221, s[32:35], s60 offen offset:0 sc1
s_waitcnt lgkmcnt(3)
v_mfma_f32_32x32x16_bf16 v[112:127], v[156:159], v[140:143], v[112:127]
ds_read_b128 v[140:143], v251 offset:0
v_add3_u32 v213, v84, v85, v86
v_add_u32_dpp v212, v212, v212 row_ror:4 row_mask:0xf bank_mask:0x5
v_add3_u32 v213, v213, v87, s89
s_nop 1
v_add_u32_dpp v212, v213, v213 row_ror:4 row_mask:0xf bank_mask:0xa
s_nop 1
v_add_u32_dpp v212, v212, v212 row_ror:8 row_mask:0xf bank_mask:0xf
buffer_store_dwordx4 v[84:87], v221, s[32:35], s60 offen offset:1024 sc1
buffer_store_dword v212, v208, s[32:35], s60 offen sc1
s_waitcnt vmcnt(11)
s_barrier
s_waitcnt lgkmcnt(3)
v_mfma_f32_32x32x16_bf16 v[112:127], v[16:19], v[128:131], v[112:127]
s_add_u32 m0, s90, 65536
s_add_u32 s91, s54, 14336
s_add_u32 s92, s54, 126976
ds_read_b128 v[128:131], v248 offset:16384
buffer_load_dwordx4 v5, s[20:23], s91 offen offset:0 lds
v_and_b32 v234, 1, v0
v_lshrrev_b32 v235, 3, v0
s_waitcnt lgkmcnt(3)
v_mfma_f32_32x32x16_bf16 v[112:127], v[20:23], v[132:135], v[112:127]
ds_read_b128 v[132:135], v249 offset:16384
buffer_load_dwordx4 v6, s[20:23], s91 offen offset:1024 lds
v_lshlrev_b32 v234, 4, v234
v_xor_b32 v235, v235, v0
v_mov_b32 v215, 0x3f80
s_waitcnt lgkmcnt(3)
v_mfma_f32_32x32x16_bf16 v[112:127], v[24:27], v[136:139], v[112:127]
ds_read_b128 v[136:139], v250 offset:16384
buffer_load_dwordx4 v5, s[20:23], s92 offen offset:2048 lds
v_and_b32 v235, 4, v235
v_lshlrev_b32 v215, v234, v215
s_waitcnt lgkmcnt(3)
v_mfma_f32_32x32x16_bf16 v[112:127], v[28:31], v[140:143], v[112:127]
ds_read_b128 v[140:143], v251 offset:16384
buffer_load_dwordx4 v6, s[20:23], s92 offen offset:3072 lds
v_bfe_u32 v234, v0, 3, 2
v_bfe_u32 v223, v0, 1, 1
s_waitcnt vmcnt(11)
s_barrier
s_waitcnt lgkmcnt(3)
v_mfma_f32_32x32x16_bf16 v[112:127], v[32:35], v[128:131], v[112:127]
s_add_u32 m0, s90, 81920
s_add_u32 s92, s58, 12288
ds_read_b64_tr_b16 v[128:129], v1 offset:32768
ds_read_b64_tr_b16 v[130:131], v1 offset:33792
buffer_load_dwordx4 v7, s[80:83], s58 offen offset:0 lds
s_lshr_b32 s2, s85, 1
v_lshl_add_u32 v235, v235, 1, v223
v_lshl_add_u32 v3, s2, 14, v3
v_lshl_add_u32 v223, v234, 1, v235
s_waitcnt lgkmcnt(4)
v_mfma_f32_32x32x16_bf16 v[112:127], v[36:39], v[132:135], v[112:127]
ds_read_b64_tr_b16 v[132:133], v1 offset:36864
ds_read_b64_tr_b16 v[134:135], v1 offset:37888
buffer_load_dwordx4 v8, s[80:83], s58 offen offset:1024 lds
v_lshl_add_u32 v219, s2, 12, v219
v_cmp_eq_u32 vcc, 0, v223
s_nop 1
v_cndmask_b32 v234, 0, v215, vcc
v_lshl_add_u32 v220, s2, 12, v220
v_cmp_eq_u32 vcc, 1, v223
s_nop 1
v_cndmask_b32 v235, 0, v215, vcc
s_waitcnt lgkmcnt(5)
v_mfma_f32_32x32x16_bf16 v[112:127], v[40:43], v[136:139], v[112:127]
ds_read_b64_tr_b16 v[136:137], v1 offset:40960
ds_read_b64_tr_b16 v[138:139], v1 offset:41984
buffer_load_dwordx4 v7, s[80:83], s92 offen offset:2048 lds
s_lshl_b32 s2, s2, 5
v_cmp_eq_u32 vcc, 2, v223
s_nop 1
v_cndmask_b32 v236, 0, v215, vcc
v_xor_b32 v219, s2, v219
v_xor_b32 v220, s2, v220
s_waitcnt lgkmcnt(6)
v_mfma_f32_32x32x16_bf16 v[112:127], v[44:47], v[140:143], v[112:127]
ds_read_b64_tr_b16 v[140:141], v1 offset:45056
ds_read_b64_tr_b16 v[142:143], v1 offset:46080
buffer_load_dwordx4 v8, s[80:83], s92 offen offset:3072 lds
s_lshl_b32 s2, s2, 3
v_cmp_eq_u32 vcc, 3, v223
s_nop 1
v_cndmask_b32 v237, 0, v215, vcc
v_xor_b32 v3, s2, v3
s_waitcnt vmcnt(11)
s_barrier
s_waitcnt lgkmcnt(6)
v_mfma_f32_32x32x16_bf16 v[112:127], v[64:67], v[128:131], v[112:127]
ds_read_b64_tr_b16 v[128:129], v1 offset:49152
ds_read_b64_tr_b16 v[130:131], v1 offset:50176
ds_read_b128 v[16:19], v3 offset:0
buffer_load_dwordx4 v[176:179], v14, s[32:35], s8 offen sc1
buffer_load_dwordx4 v[180:183], v14, s[32:35], s9 offen sc1
buffer_load_dword v238, v222, s[32:35], s8 offen sc1
s_waitcnt lgkmcnt(7)
v_mfma_f32_32x32x16_bf16 v[112:127], v[68:71], v[132:135], v[112:127]
ds_read_b64_tr_b16 v[132:133], v1 offset:53248
ds_read_b64_tr_b16 v[134:135], v1 offset:54272
ds_read_b128 v[20:23], v3 offset:1024
s_lshl_b32 s94, s84, 11
s_add_u32 s94, s94, 8192
v_lshl_add_u32 v210, v0, 4, s94
v_xor_b32 v211, 4096, v210
s_waitcnt lgkmcnt(8)
v_mfma_f32_32x32x16_bf16 v[112:127], v[72:75], v[136:139], v[112:127]
ds_read_b64_tr_b16 v[136:137], v1 offset:57344
ds_read_b64_tr_b16 v[138:139], v1 offset:58368
ds_read_b128 v[24:27], v3 offset:2048
s_waitcnt lgkmcnt(9)
v_mfma_f32_32x32x16_bf16 v[112:127], v[76:79], v[140:143], v[112:127]
ds_read_b64_tr_b16 v[140:141], v1 offset:61440
ds_read_b64_tr_b16 v[142:143], v1 offset:62464
ds_read_b128 v[28:31], v3 offset:3072
s_waitcnt vmcnt(7)
s_barrier
s_waitcnt lgkmcnt(9)
v_mfma_f32_32x32x16_bf16 v[160:175], v[16:19], v[128:131], v[160:175]
ds_read_b64_tr_b16 v[128:129], v2 offset:0
ds_read_b64_tr_b16 v[130:131], v2 offset:1024
ds_read_b128 v[32:35], v3 offset:4096
s_add_u32 s71, s61, 14336
s_nop 0
v_cvt_pk_bf16_f32 v112, v112, v113
v_cvt_pk_bf16_f32 v113, v114, v115
v_cvt_pk_bf16_f32 v114, v116, v117
v_cvt_pk_bf16_f32 v115, v118, v119
v_cvt_pk_bf16_f32 v116, v120, v121
s_cmp_eq_u32 s39, 0
s_cbranch_scc1 SA1
buffer_store_dwordx4 v[112:115], v214, s[76:79], s61 offen
SB1:
s_waitcnt lgkmcnt(9)
v_mfma_f32_32x32x16_bf16 v[160:175], v[20:23], v[132:135], v[160:175]
ds_read_b64_tr_b16 v[132:133], v2 offset:4096
ds_read_b64_tr_b16 v[134:135], v2 offset:5120
ds_read_b128 v[36:39], v3 offset:5120
v_add3_u32 v212, v112, v113, v114
v_cvt_pk_bf16_f32 v117, v122, v123
v_add3_u32 v212, v212, v115, s89
v_cvt_pk_bf16_f32 v118, v124, v125
v_cvt_pk_bf16_f32 v119, v126, v127
s_waitcnt lgkmcnt(9)
v_mfma_f32_32x32x16_bf16 v[160:175], v[24:27], v[136:139], v[160:175]
ds_read_b64_tr_b16 v[136:137], v2 offset:8192
ds_read_b64_tr_b16 v[138:139], v2 offset:9216
ds_read_b128 v[40:43], v3 offset:6144
v_add3_u32 v213, v116, v117, v118
v_add_u32_dpp v212, v212, v212 row_ror:4 row_mask:0xf bank_mask:0x5
v_add3_u32 v213, v213, v119, s89
s_nop 1
v_add_u32_dpp v212, v213, v213 row_ror:4 row_mask:0xf bank_mask:0xa
s_nop 1
v_add_u32_dpp v212, v212, v212 row_ror:8 row_mask:0xf bank_mask:0xf
s_cmp_eq_u32 s39, 0
s_cbranch_scc1 SA2
buffer_store_dwordx4 v[116:119], v214, s[76:79], s71 offen
SB2:
s_waitcnt lgkmcnt(9)
v_mfma_f32_32x32x16_bf16 v[160:175], v[28:31], v[140:143], v[160:175]
ds_read_b64_tr_b16 v[140:141], v2 offset:12288
ds_read_b64_tr_b16 v[142:143], v2 offset:13312
ds_read_b128 v[44:47], v3 offset:7168
s_cmp_eq_u32 s39, 0
s_cbranch_scc1 SA3
buffer_store_dword v212, v208, s[32:35], s99 offen
SB3:
s_waitcnt vmcnt(6)
s_barrier
s_waitcnt lgkmcnt(9)
v_mfma_f32_32x32x16_bf16 v[160:175], v[32:35], v[128:131], v[160:175]
ds_read_b128 v[128:131], v252 offset:16384
ds_read_b64_tr_b16 v[48:49], v219 offset:0
ds_read_b64_tr_b16 v[50:51], v220 offset:0
s_waitcnt lgkmcnt(9)
v_mfma_f32_32x32x16_bf16 v[160:175], v[36:39], v[132:135], v[160:175]
ds_read_b128 v[132:135], v253 offset:16384
ds_read_b64_tr_b16 v[52:53], v219 offset:1024
ds_read_b64_tr_b16 v[54:55], v220 offset:1024
s_waitcnt lgkmcnt(9)
v_mfma_f32_32x32x16_bf16 v[160:175], v[40:43], v[136:139], v[160:175]
ds_read_b128 v[136:139], v254 offset:16384
ds_read_b64_tr_b16 v[56:57], v219 offset:2048
ds_read_b64_tr_b16 v[58:59], v220 offset:2048
s_waitcnt lgkmcnt(9)
v_mfma_f32_32x32x16_bf16 v[160:175], v[44:47], v[140:143], v[160:175]
ds_read_b128 v[140:143], v255 offset:16384
ds_read_b64_tr_b16 v[60:61], v219 offset:3072
ds_read_b64_tr_b16 v[62:63], v220 offset:3072
s_barrier
s_waitcnt lgkmcnt(9)
v_mfma_f32_32x32x16_bf16 v[160:175], v[48:51], v[128:131], v[160:175]
buffer_load_dwordx4 v[184:187], v14, s[32:35], s10 offen sc1
s_waitcnt vmcnt(6)
v_add3_u32 v223, v176, v177, v178
s_waitcnt vmcnt(5)
v_add3_u32 v215, v180, v181, v182
v_add3_u32 v223, v223, v179, s98
v_add3_u32 v223, v223, v215, v183
s_waitcnt vmcnt(4)
v_add_u32_dpp v215, v238, v238 row_ror:4 row_mask:0xf bank_mask:0xf
v_add_u32_dpp v223, v223, v223 row_ror:4 row_mask:0xf bank_mask:0xf
s_nop 1
v_add_u32_dpp v223, v223, v223 row_ror:8 row_mask:0xf bank_mask:0xf
v_cmp_ne_u32 vcc, v223, v215
s_nop 0
s_cmp_lg_u64 vcc, 0
s_cbranch_scc1 RG0L
BG0L:
buffer_load_dwordx4 v[188:191], v14, s[32:35], s11 offen sc1
buffer_load_dword v239, v222, s[32:35], s10 offen sc1
s_waitcnt lgkmcnt(6)
v_mfma_f32_32x32x16_bf16 v[160:175], v[52:55], v[132:135], v[160:175]
v_mfma_f32_32x32x16_bf16 v[160:175], v[234:237], v[176:179], v[160:175]
s_waitcnt lgkmcnt(3)
v_mfma_f32_32x32x16_bf16 v[160:175], v[56:59], v[136:139], v[160:175]
v_mfma_f32_32x32x16_bf16 v[160:175], v[234:237], v[180:183], v[160:175]
s_waitcnt lgkmcnt(0)
v_mfma_f32_32x32x16_bf16 v[160:175], v[60:63], v[140:143], v[160:175]
s_branch TAIL
.p2align 12
PADS0:
s_cbranch_execz HOPB
ROLES:
s_waitcnt vmcnt(15)
s_waitcnt lgkmcnt(0)
s_or_b32 s89, s89, 1
s_add_u32 s89, s89, 1013904242
s_barrier
ds_read_b128 v[128:131], v248 offset:0
ds_read_b128 v[16:19], v208 offset:0
v_bfe_u32 v179, v0, 3, 1
v_lshl_add_u32 v1, v155, 3, v1
s_mov_b32 s44, 3237186
s_waitcnt vmcnt(14)
v_lshlrev_b32 v178, 16, v178
s_lshr_b32 s94, s85, 1
ds_read_b128 v[132:135], v249 offset:0
ds_read_b128 v[20:23], v209 offset:0
s_waitcnt vmcnt(13)
v_lshlrev_b32 v176, 16, v176
s_lshl_b32 s94, s94, 11
s_mov_b32 s98, 2184246
s_waitcnt vmcnt(11)
v_lshlrev_b32 v177, 16, v177
s_add_u32 s94, s94, 8192
v_add_u32 v1, s94, v1
ds_read_b128 v[136:139], v250 offset:0
ds_read_b128 v[24:27], v210 offset:0
v_mul_f32 v178, 0x3fb8aa3b, v178
s_lshl_b32 s94, s86, 13
v_lshlrev_b32 v179, 31, v179
s_add_u32 s94, s94, 106496
ds_read_b128 v[140:143], v251 offset:0
ds_read_b128 v[28:31], v211 offset:0
v_exp_f32 v178, v178
v_add_u32 v2, 0x10000, v1
s_cmp_eq_u32 s88, 1
s_cselect_b32 s44, 152630, s44
s_cselect_b32 s98, 156995, s98
v_mul_f32 v182, v176, v176
v_lshl_add_u32 v3, v0, 4, s94
s_waitcnt vmcnt(9)
s_barrier
s_waitcnt lgkmcnt(6)
v_mfma_f32_32x32x16_bf16 v[160:175], v[16:19], v[128:131], 0
ds_read_b128 v[128:131], v248 offset:16384
ds_read_b128 v[32:35], v208 offset:1024
v_fmac_f32 v182, v177, v177
v_lshlrev_b32 v247, 3, v150
s_getreg_b32 s45, hwreg(HW_REG_XCC_ID, 0, 4)
s_andn2_b32 s71, s89, 15
s_or_b32 s45, s45, s71
v_cvt_pk_bf16_f32 v178, v178, v178
s_waitcnt lgkmcnt(6)
v_mfma_f32_32x32x16_bf16 v[160:175], v[20:23], v[132:135], v[160:175]
ds_read_b128 v[132:135], v249 offset:16384
ds_read_b128 v[36:39], v209 offset:1024
v_rcp_f32 v182, v182
v_lshl_add_u32 v4, s85, 10, v3
s_waitcnt lgkmcnt(6)
v_mfma_f32_32x32x16_bf16 v[160:175], v[24:27], v[136:139], v[160:175]
ds_read_b128 v[136:139], v250 offset:16384
ds_read_b128 v[40:43], v210 offset:1024
v_lshlrev_b32 v178, 16, v178
v_lshl_add_u32 v247, s85, 8, v247
v_mul_f32 v180, v178, v176
v_mul_f32 v181, v178, v177
s_waitcnt lgkmcnt(6)
v_mfma_f32_32x32x16_bf16 v[160:175], v[28:31], v[140:143], v[160:175]
ds_read_b128 v[140:143], v251 offset:16384
ds_read_b128 v[44:47], v211 offset:1024
v_mul_f32 v180, 0x3fb8aa3b, v180
v_bfe_u32 v156, v0, 2, 1
s_cmp_eq_u32 s88, 2
s_cselect_b32 s44, 1261669, s44
s_cselect_b32 s98, 1062484, s98
v_mul_f32 v181, 0.15915494309189532, v181
s_waitcnt vmcnt(6)
s_barrier
s_waitcnt lgkmcnt(6)
v_mfma_f32_32x32x16_bf16 v[160:175], v[32:35], v[128:131], v[160:175]
ds_read_b128 v[128:131], v248 offset:32768
ds_read_b128 v[48:51], v208 offset:2048
v_exp_f32 v180, v180
v_lshlrev_b32 v194, 1, v247
v_lshlrev_b32 v222, 4, v155
s_waitcnt lgkmcnt(6)
v_mfma_f32_32x32x16_bf16 v[160:175], v[36:39], v[132:135], v[160:175]
ds_read_b128 v[132:135], v249 offset:32768
ds_read_b128 v[52:55], v209 offset:2048
v_fract_f32 v181, v181
v_lshl_add_u32 v222, v156, 8, v222
v_cos_f32 v183, v181
s_waitcnt lgkmcnt(6)
v_mfma_f32_32x32x16_bf16 v[160:175], v[40:43], v[136:139], v[160:175]
ds_read_b128 v[136:139], v250 offset:32768
ds_read_b128 v[56:59], v210 offset:2048
v_sin_f32 v184, v181
v_lshl_add_u32 v222, v148, 6, v222
s_cmp_eq_u32 s88, 3
s_cselect_b32 s44, 2102868, s44
s_cselect_b32 s98, 6562053, s98
s_waitcnt lgkmcnt(6)
v_mfma_f32_32x32x16_bf16 v[160:175], v[44:47], v[140:143], v[160:175]
ds_read_b128 v[140:143], v251 offset:32768
ds_read_b128 v[60:63], v211 offset:2048
v_add_f32 v182, v182, v182
v_lshl_add_u32 v222, s86, 9, v222
v_mul_f32 v9, v183, v180
s_waitcnt vmcnt(3)
s_barrier
s_waitcnt lgkmcnt(6)
v_mfma_f32_32x32x16_bf16 v[160:175], v[48:51], v[128:131], v[160:175]
ds_read_b128 v[128:131], v248 offset:49152
ds_read_b128 v[64:67], v208 offset:3072
v_mul_f32 v184, v184, v180
s_lshl_b32 s41, s87, 3
s_add_u32 s41, s41, s88
s_lshl_b32 s41, s41, 8
s_add_u32 s41, s41, 655360
s_cmp_eq_u32 s85, 0
s_cselect_b32 s41, s41, 0x40000000
v_mov_b32 v198, s45
v_lshlrev_b32 v199, 2, v0
buffer_store_dword v198, v199, s[32:35], s41 offen sc1
v_lshl_add_u32 v218, v154, 3, v146
v_add_f32 v183, -1.0, v9
s_waitcnt lgkmcnt(6)
v_mfma_f32_32x32x16_bf16 v[160:175], v[52:55], v[132:135], v[160:175]
ds_read_b128 v[132:135], v249 offset:49152
ds_read_b128 v[68:71], v209 offset:3072
v_xor_b32 v10, v179, v184
v_lshl_add_u32 v193, v147, 30, v222
s_cmp_eq_u32 s88, 4
s_cselect_b32 s44, 6627587, s44
s_cselect_b32 s98, 3477602, s98
v_mul_f32 v185, v183, v176
s_waitcnt lgkmcnt(6)
v_mfma_f32_32x32x16_bf16 v[160:175], v[56:59], v[136:139], v[160:175]
ds_read_b128 v[136:139], v250 offset:49152
ds_read_b128 v[72:75], v210 offset:3072
v_mul_f32 v186, v183, v177
v_lshl_add_u32 v218, s85, 4, v218
v_fmac_f32 v185, v184, v177
s_add_u32 s94, s94, 32768
v_fma_f32 v186, -v184, v176, v186
s_waitcnt lgkmcnt(6)
v_mfma_f32_32x32x16_bf16 v[160:175], v[60:63], v[140:143], v[160:175]
ds_read_b128 v[140:143], v251 offset:49152
ds_read_b128 v[76:79], v211 offset:3072
v_mul_f32 v185, v185, v182
v_bfe_u32 v156, v218, 1, 2
v_mul_f32 v227, v186, v182
v_and_b32 v157, 1, v144
s_waitcnt vmcnt(3)
s_barrier
s_waitcnt lgkmcnt(6)
v_mfma_f32_32x32x16_bf16 v[160:175], v[64:67], v[128:131], v[160:175]
ds_read_b128 v[128:131], v252 offset:0
ds_read_b128 v[80:83], v208 offset:4096
v_xor_b32 v226, v179, v185
v_xor_b32 v156, v147, v156
s_cmp_eq_u32 s88, 5
s_cselect_b32 s44, 4600336, s44
s_cselect_b32 s98, 4588321, s98
v_mul_f32 v187, v10, v10
s_waitcnt lgkmcnt(6)
v_mfma_f32_32x32x16_bf16 v[160:175], v[68:71], v[132:135], v[160:175]
ds_read_b128 v[132:135], v253 offset:0
ds_read_b128 v[84:87], v209 offset:4096
v_add_f32 v188, v9, v9
v_lshl_add_u32 v218, v218, 6, s94
v_fma_f32 v180, v9, v9, -v187
s_waitcnt lgkmcnt(6)
v_mfma_f32_32x32x16_bf16 v[160:175], v[72:75], v[136:139], v[160:175]
ds_read_b128 v[136:139], v254 offset:0
ds_read_b128 v[88:91], v210 offset:4096
v_mul_f32 v181, v188, v10
v_lshl_add_u32 v218, v156, 4, v218
v_mul_f32 v187, v181, v181
v_add_f32 v188, v180, v180
s_waitcnt lgkmcnt(6)
v_mfma_f32_32x32x16_bf16 v[160:175], v[76:79], v[140:143], v[160:175]
ds_read_b128 v[140:143], v255 offset:0
ds_read_b128 v[92:95], v211 offset:4096
v_fma_f32 v182, v180, v180, -v187
v_xor_b32 v156, v158, v157
s_cmp_eq_u32 s88, 6
s_cselect_b32 s44, 5505825, s44
s_cselect_b32 s98, 5456400, s98
v_mul_f32 v183, v188, v181
s_waitcnt vmcnt(2)
s_barrier
s_waitcnt lgkmcnt(6)
v_mfma_f32_32x32x16_bf16 v[160:175], v[80:83], v[128:131], v[160:175]
ds_read_b128 v[128:131], v252 offset:16384
ds_read_b128 v[96:99], v208 offset:5120
v_mul_f32 v187, v183, v183
v_lshl_add_u32 v218, v157, 12, v218
v_add_f32 v188, v182, v182
v_lshl_add_u32 v156, v154, 1, v156
s_waitcnt lgkmcnt(6)
v_mfma_f32_32x32x16_bf16 v[160:175], v[84:87], v[132:135], v[160:175]
ds_read_b128 v[132:135], v253 offset:16384
ds_read_b128 v[100:103], v209 offset:5120
v_fma_f32 v11, v182, v182, -v187
v_bfe_u32 v157, v0, 1, 1
v_mul_f32 v12, v188, v183
s_waitcnt lgkmcnt(6)
v_mfma_f32_32x32x16_bf16 v[160:175], v[88:91], v[136:139], v[160:175]
ds_read_b128 v[136:139], v254 offset:16384
ds_read_b128 v[104:107], v210 offset:5120
v_mul_f32 v187, v12, v12
v_lshl_add_u32 v219, v147, 9, s94
s_bitcmp1_b32 s87, 2
s_cselect_b32 s44, s98, s44
v_add_f32 v188, v11, v11
v_fma_f32 v13, v11, v11, -v187
s_waitcnt lgkmcnt(6)
v_mfma_f32_32x32x16_bf16 v[160:175], v[92:95], v[140:143], v[160:175]
ds_read_b128 v[140:143], v255 offset:16384
ds_read_b128 v[108:111], v211 offset:5120
v_mul_f32 v14, v188, v12
v_lshl_add_u32 v156, v156, 1, v157
v_mul_f32 v187, v14, v14
s_waitcnt vmcnt(1)
s_barrier
s_waitcnt lgkmcnt(6)
v_mfma_f32_32x32x16_bf16 v[160:175], v[96:99], v[128:131], v[160:175]
ds_read_b128 v[128:131], v248 offset:0
ds_read_b128 v[112:115], v208 offset:6144
v_add_f32 v188, v13, v13
v_lshl_add_u32 v219, v152, 6, v219
s_and_b32 s2, s85, 2
v_fma_f32 v228, v13, v13, -v187
s_and_b32 s94, s85, 1
s_lshl_b32 s95, s86, 1
s_waitcnt lgkmcnt(6)
v_mfma_f32_32x32x16_bf16 v[160:175], v[100:103], v[132:135], v[160:175]
ds_read_b128 v[132:135], v249 offset:0
ds_read_b128 v[116:119], v209 offset:6144
v_mul_f32 v229, v188, v14
s_add_u32 s94, s94, s95
s_lshl_b32 s2, s2, 1
v_mul_f32 v180, v13, v228
s_lshl_b32 s94, s94, 11
v_lshl_add_u32 v219, v156, 3, v219
s_waitcnt lgkmcnt(6)
v_mfma_f32_32x32x16_bf16 v[160:175], v[104:107], v[136:139], v[160:175]
ds_read_b128 v[136:139], v250 offset:0
ds_read_b128 v[120:123], v210 offset:6144
v_mul_f32 v181, v13, v229
v_lshl_add_u32 v221, v0, 4, s94
s_lshr_b32 s2, s44, s2
v_fma_f32 v180, -v14, v229, v180
v_fmac_f32 v181, v14, v228
s_waitcnt lgkmcnt(6)
v_mfma_f32_32x32x16_bf16 v[160:175], v[108:111], v[140:143], v[160:175]
ds_read_b128 v[140:143], v251 offset:0
ds_read_b128 v[124:127], v211 offset:6144
v_cndmask_b32 v224, v228, v180, s[96:97]
v_xor_b32 v220, 0x120, v219
s_bfe_u32 s37, s2, 0x30010
v_cndmask_b32 v225, v229, v181, s[96:97]
s_barrier
s_waitcnt lgkmcnt(6)
v_mfma_f32_32x32x16_bf16 v[160:175], v[112:115], v[128:131], v[160:175]
ds_read_b64_tr_b16 v[128:129], v1 offset:16384
ds_read_b64_tr_b16 v[130:131], v1 offset:17408
s_waitcnt lgkmcnt(6)
v_mfma_f32_32x32x16_bf16 v[160:175], v[116:119], v[132:135], v[160:175]
ds_read_b64_tr_b16 v[132:133], v1 offset:20480
ds_read_b64_tr_b16 v[134:135], v1 offset:21504
ds_read_b64_tr_b16 v[230:231], v195
ds_read_b64_tr_b16 v[232:233], v196 offset:7168
s_waitcnt lgkmcnt(8)
v_mfma_f32_32x32x16_bf16 v[160:175], v[120:123], v[136:139], v[160:175]
ds_read_b64_tr_b16 v[136:137], v1 offset:24576
ds_read_b64_tr_b16 v[138:139], v1 offset:25600
s_waitcnt lgkmcnt(8)
v_mfma_f32_32x32x16_bf16 v[160:175], v[124:127], v[140:143], v[160:175]
ds_read_b64_tr_b16 v[140:141], v1 offset:28672
ds_read_b64_tr_b16 v[142:143], v1 offset:29696
s_barrier
s_waitcnt lgkmcnt(8)
v_mfma_f32_32x32x16_bf16 v[144:159], v[128:131], v[16:19], 0
ds_read_b64_tr_b16 v[128:129], v1 offset:32768
ds_read_b64_tr_b16 v[130:131], v1 offset:33792
s_nop 4
v_fma_f32 v238, v9, v160, v161
v_fma_f32 v240, v9, v168, v169
s_nop 0
v_fmac_f32_dpp v238, v160, -v10 row_ror:8 row_mask:0xf bank_mask:0xf
v_fmac_f32_dpp v240, v168, -v10 row_ror:8 row_mask:0xf bank_mask:0xf
v_fma_f32 v239, v9, v238, v162
s_waitcnt lgkmcnt(8)
v_mfma_f32_32x32x16_bf16 v[144:159], v[132:135], v[20:23], v[144:159]
ds_read_b64_tr_b16 v[132:133], v1 offset:36864
ds_read_b64_tr_b16 v[134:135], v1 offset:37888
v_fma_f32 v241, v9, v240, v170
v_fmac_f32_dpp v239, v238, -v10 row_ror:8 row_mask:0xf bank_mask:0xf
s_nop 0
v_fmac_f32_dpp v241, v240, -v10 row_ror:8 row_mask:0xf bank_mask:0xf
v_fma_f32 v238, v9, v239, v163
s_waitcnt lgkmcnt(6)
v_mfma_f32_32x32x16_bf16 v[144:159], v[136:139], v[24:27], v[144:159]
ds_read_b64_tr_b16 v[136:137], v1 offset:40960
ds_read_b64_tr_b16 v[138:139], v1 offset:41984
v_fma_f32 v240, v9, v241, v171
v_fmac_f32_dpp v238, v239, -v10 row_ror:8 row_mask:0xf bank_mask:0xf
s_nop 0
v_fmac_f32_dpp v240, v241, -v10 row_ror:8 row_mask:0xf bank_mask:0xf
v_fma_f32 v239, v9, v238, v164
v_fma_f32 v241, v9, v240, v172
s_waitcnt lgkmcnt(6)
v_mfma_f32_32x32x16_bf16 v[144:159], v[140:143], v[28:31], v[144:159]
ds_read_b64_tr_b16 v[140:141], v1 offset:45056
ds_read_b64_tr_b16 v[142:143], v1 offset:46080
v_fmac_f32_dpp v239, v238, -v10 row_ror:8 row_mask:0xf bank_mask:0xf
buffer_load_dwordx4 v[234:237], v222, s[32:35], s75 offen sc1
v_fmac_f32_dpp v241, v240, -v10 row_ror:8 row_mask:0xf bank_mask:0xf
buffer_load_dwordx4 v[208:211], v193, s[32:35], s36 offen sc1
v_fma_f32 v238, v9, v239, v165
v_fma_f32 v240, v9, v241, v173
s_nop 0
v_fmac_f32_dpp v238, v239, -v10 row_ror:8 row_mask:0xf bank_mask:0xf
s_barrier
s_waitcnt lgkmcnt(6)
v_mfma_f32_32x32x16_bf16 v[144:159], v[128:131], v[32:35], v[144:159]
ds_read_b64_tr_b16 v[128:129], v1 offset:49152
ds_read_b64_tr_b16 v[130:131], v1 offset:50176
v_fmac_f32_dpp v240, v241, -v10 row_ror:8 row_mask:0xf bank_mask:0xf
v_fma_f32 v239, v9, v238, v166
v_fma_f32 v241, v9, v240, v174
s_nop 0
v_fmac_f32_dpp v239, v238, -v10 row_ror:8 row_mask:0xf bank_mask:0xf
v_fmac_f32_dpp v241, v240, -v10 row_ror:8 row_mask:0xf bank_mask:0xf
s_waitcnt lgkmcnt(6)
v_mfma_f32_32x32x16_bf16 v[144:159], v[132:135], v[36:39], v[144:159]
ds_read_b64_tr_b16 v[132:133], v1 offset:53248
ds_read_b64_tr_b16 v[134:135], v1 offset:54272
v_fma_f32 v238, v9, v239, v167
v_fma_f32 v240, v9, v241, v175
s_nop 0
v_fmac_f32_dpp v238, v239, -v10 row_ror:8 row_mask:0xf bank_mask:0xf
v_fmac_f32_dpp v240, v241, -v10 row_ror:8 row_mask:0xf bank_mask:0xf
s_waitcnt lgkmcnt(6)
v_mfma_f32_32x32x16_bf16 v[144:159], v[136:139], v[40:43], v[144:159]
ds_read_b64_tr_b16 v[136:137], v1 offset:57344
ds_read_b64_tr_b16 v[138:139], v1 offset:58368
v_fma_f32 v245, v11, v238, v240
v_mul_f32_dpp v246, v238, v227 row_ror:8 row_mask:0xf bank_mask:0xf
s_nop 0
v_fmac_f32_dpp v245, v238, -v12 row_ror:8 row_mask:0xf bank_mask:0xf
v_fma_f32 v242, v226, v238, v246
v_mul_f32 v244, v226, v245
s_waitcnt lgkmcnt(6)
v_mfma_f32_32x32x16_bf16 v[144:159], v[140:143], v[44:47], v[144:159]
ds_read_b64_tr_b16 v[140:141], v1 offset:61440
ds_read_b64_tr_b16 v[142:143], v1 offset:62464
v_fmac_f32_dpp v244, v245, v227 row_ror:8 row_mask:0xf bank_mask:0xf
v_mov_b32 v223, v244
s_nop 1
v_permlane32_swap_b32 v244, v223
v_fma_f32 v223, v13, v244, v223
s_nop 1
v_fmac_f32_dpp v223, v244, v14 row_ror:8 row_mask:0xf bank_mask:0xf
s_barrier
s_waitcnt lgkmcnt(6)
v_mfma_f32_32x32x16_bf16 v[144:159], v[128:131], v[48:51], v[144:159]
ds_read_b64_tr_b16 v[128:129], v2 offset:0
ds_read_b64_tr_b16 v[130:131], v2 offset:1024
ds_read_b32 v238, v247 offset:1024
s_waitcnt lgkmcnt(7)
v_mfma_f32_32x32x16_bf16 v[144:159], v[132:135], v[52:55], v[144:159]
ds_read_b64_tr_b16 v[132:133], v2 offset:4096
ds_read_b64_tr_b16 v[134:135], v2 offset:5120
s_waitcnt lgkmcnt(2)
v_fma_f32 v216, v228, v238, v223
s_nop 1
v_fmac_f32_dpp v216, v238, v229 row_ror:8 row_mask:0xf bank_mask:0xf
v_mov_b32 v217, s89
buffer_store_dwordx2 v[216:217], v247, s[32:35], s72 offen sc1
v_fma_f32 v239, v13, v238, v244
s_nop 1
v_fmac_f32_dpp v239, v238, v14 row_ror:8 row_mask:0xf bank_mask:0xf
v_cndmask_b32 v243, v238, v239, s[96:97]
v_mfma_f32_32x32x16_bf16 v[144:159], v[136:139], v[56:59], v[144:159]
ds_read_b64_tr_b16 v[136:137], v2 offset:8192
ds_read_b64_tr_b16 v[138:139], v2 offset:9216
v_mfma_f32_32x32x16_bf16 v[144:159], v[140:143], v[60:63], v[144:159]
ds_read_b64_tr_b16 v[140:141], v2 offset:12288
ds_read_b64_tr_b16 v[142:143], v2 offset:13312
buffer_load_dwordx4 v[212:215], v194, s[32:35], s74 offen offset:0 sc1
s_barrier
v_mfma_f32_32x32x16_bf16 v[144:159], v[128:131], v[64:67], v[144:159]
ds_read_b64_tr_b16 v[128:129], v2 offset:16384
ds_read_b64_tr_b16 v[130:131], v2 offset:17408
v_mul_f32_dpp v245, v160, v227 row_ror:8 row_mask:0xf bank_mask:0xf
v_mul_f32_dpp v246, v161, v227 row_ror:8 row_mask:0xf bank_mask:0xf
s_waitcnt lgkmcnt(6)
v_mfma_f32_32x32x16_bf16 v[144:159], v[132:135], v[68:71], v[144:159]
ds_read_b64_tr_b16 v[132:133], v2 offset:20480
ds_read_b64_tr_b16 v[134:135], v2 offset:21504
v_fma_f32 v160, v226, v160, v245
v_fma_f32 v161, v226, v161, v246
s_waitcnt lgkmcnt(6)
v_mfma_f32_32x32x16_bf16 v[144:159], v[136:139], v[72:75], v[144:159]
ds_read_b64_tr_b16 v[136:137], v2 offset:24576
ds_read_b64_tr_b16 v[138:139], v2 offset:25600
v_mul_f32_dpp v245, v162, v227 row_ror:8 row_mask:0xf bank_mask:0xf
v_mul_f32_dpp v246, v163, v227 row_ror:8 row_mask:0xf bank_mask:0xf
s_waitcnt lgkmcnt(6)
v_mfma_f32_32x32x16_bf16 v[144:159], v[140:143], v[76:79], v[144:159]
ds_read_b64_tr_b16 v[140:141], v2 offset:28672
ds_read_b64_tr_b16 v[142:143], v2 offset:29696
v_fma_f32 v162, v226, v162, v245
v_fma_f32 v163, v226, v163, v246
s_barrier
s_waitcnt lgkmcnt(6)
v_mfma_f32_32x32x16_bf16 v[144:159], v[128:131], v[80:83], v[144:159]
ds_read_b64_tr_b16 v[128:129], v1 offset:0
ds_read_b64_tr_b16 v[130:131], v1 offset:1024
v_mul_f32_dpp v245, v164, v227 row_ror:8 row_mask:0xf bank_mask:0xf
v_mul_f32_dpp v246, v165, v227 row_ror:8 row_mask:0xf bank_mask:0xf
s_waitcnt lgkmcnt(6)
v_mfma_f32_32x32x16_bf16 v[144:159], v[132:135], v[84:87], v[144:159]
ds_read_b64_tr_b16 v[132:133], v1 offset:4096
ds_read_b64_tr_b16 v[134:135], v1 offset:5120
s_waitcnt vmcnt(3)
v_cmp_ne_u32 vcc, s89, v237
s_waitcnt vmcnt(2)
v_cmp_ne_u32 s[40:41], s89, v211
s_nop 0
s_or_b32 s40, s40, vcc_lo
s_cbranch_scc1 RSTS
BSTS:
v_fma_f32 v164, v226, v164, v245
v_mul_f32 v223, v234, v234
v_fma_f32 v165, v226, v165, v246
v_lshrrev_b32 v222, 2, v222
v_mul_f32 v223, 0x3c0a3963, v223
ds_write_b32 v222, v236 offset:0
v_mov_b32 v211, 0
v_mul_f32 v237, v223, v234
s_waitcnt lgkmcnt(7)
v_mfma_f32_32x32x16_bf16 v[144:159], v[136:139], v[88:91], v[144:159]
ds_read_b64_tr_b16 v[136:137], v1 offset:8192
ds_read_b64_tr_b16 v[138:139], v1 offset:9216
v_mul_f32_dpp v245, v166, v227 row_ror:8 row_mask:0xf bank_mask:0xf
v_mul_f32_dpp v246, v167, v227 row_ror:8 row_mask:0xf bank_mask:0xf
s_waitcnt lgkmcnt(7)
v_mfma_f32_32x32x16_bf16 v[144:159], v[140:143], v[92:95], v[144:159]
ds_read_b64_tr_b16 v[140:141], v1 offset:12288
ds_read_b64_tr_b16 v[142:143], v1 offset:13312
v_fma_f32 v166, v226, v166, v245
v_min_u32 v199, 6, v0
v_fma_f32 v167, v226, v167, v246
v_lshlrev_b32 v199, 8, v199
s_lshl_b32 s41, s87, 11
s_add_u32 s41, s41, 655360
buffer_load_dword v198, v199, s[32:35], s41 offen sc1
s_barrier
s_waitcnt lgkmcnt(7)
v_mfma_f32_32x32x16_bf16 v[144:159], v[128:131], v[96:99], v[144:159]
ds_read_b64_tr_b16 v[128:129], v1 offset:16384
ds_read_b64_tr_b16 v[130:131], v1 offset:17408
v_mul_f32_dpp v245, v168, v227 row_ror:8 row_mask:0xf bank_mask:0xf
v_mul_f32_dpp v246, v169, v227 row_ror:8 row_mask:0xf bank_mask:0xf
s_waitcnt lgkmcnt(7)
v_mfma_f32_32x32x16_bf16 v[144:159], v[132:135], v[100:103], v[144:159]
ds_read_b64_tr_b16 v[132:133], v1 offset:20480
ds_read_b64_tr_b16 v[134:135], v1 offset:21504
v_fma_f32 v168, v226, v168, v245
v_fma_f32 v169, v226, v169, v246
s_waitcnt lgkmcnt(6)
v_mfma_f32_32x32x16_bf16 v[144:159], v[136:139], v[104:107], v[144:159]
ds_read_b64_tr_b16 v[136:137], v1 offset:24576
ds_read_b64_tr_b16 v[138:139], v1 offset:25600
s_waitcnt vmcnt(1)
v_cmp_ne_u32 vcc, s89, v215
s_nop 0
s_cmp_lg_u64 vcc, 0
s_cbranch_scc1 RCS0S
BCS0S:
v_mul_f32_dpp v245, v170, v227 row_ror:8 row_mask:0xf bank_mask:0xf
v_mov_b32 v215, 0
v_mul_f32_dpp v246, v171, v227 row_ror:8 row_mask:0xf bank_mask:0xf
s_waitcnt lgkmcnt(6)
v_mfma_f32_32x32x16_bf16 v[144:159], v[140:143], v[108:111], v[144:159]
ds_read_b64_tr_b16 v[140:141], v1 offset:28672
ds_read_b64_tr_b16 v[142:143], v1 offset:29696
v_fma_f32 v170, v226, v170, v245
v_fma_f32 v171, v226, v171, v246
s_barrier
s_waitcnt lgkmcnt(6)
v_mfma_f32_32x32x16_bf16 v[144:159], v[128:131], v[112:115], v[144:159]
ds_read_b64_tr_b16 v[128:129], v1 offset:32768
ds_read_b64_tr_b16 v[130:131], v1 offset:33792
v_mul_f32_dpp v245, v172, v227 row_ror:8 row_mask:0xf bank_mask:0xf
v_mul_f32_dpp v246, v173, v227 row_ror:8 row_mask:0xf bank_mask:0xf
s_waitcnt lgkmcnt(6)
v_mfma_f32_32x32x16_bf16 v[144:159], v[132:135], v[116:119], v[144:159]
ds_read_b64_tr_b16 v[132:133], v1 offset:36864
ds_read_b64_tr_b16 v[134:135], v1 offset:37888
v_mfma_f32_32x32x16_bf16 v[144:159], v[212:215], v[208:211], v[144:159]
v_fma_f32 v172, v226, v172, v245
v_fma_f32 v173, v226, v173, v246
s_waitcnt lgkmcnt(6)
v_mfma_f32_32x32x16_bf16 v[144:159], v[136:139], v[120:123], v[144:159]
ds_read_b64_tr_b16 v[136:137], v1 offset:40960
ds_read_b64_tr_b16 v[138:139], v1 offset:41984
v_mul_f32_dpp v245, v174, v227 row_ror:8 row_mask:0xf bank_mask:0xf
v_mul_f32_dpp v246, v175, v227 row_ror:8 row_mask:0xf bank_mask:0xf
s_waitcnt lgkmcnt(6)
v_mfma_f32_32x32x16_bf16 v[144:159], v[140:143], v[124:127], v[144:159]
ds_read_b64_tr_b16 v[140:141], v1 offset:45056
ds_read_b64_tr_b16 v[142:143], v1 offset:46080
v_fma_f32 v174, v226, v174, v245
v_fma_f32 v175, v226, v175, v246
s_barrier
s_waitcnt lgkmcnt(6)
v_mfma_f32_32x32x16_bf16 v[176:191], v[128:131], v[16:19], 0
ds_read_b64_tr_b16 v[128:129], v1 offset:49152
ds_read_b64_tr_b16 v[130:131], v1 offset:50176
s_nop 2
v_mul_f32 v238, v144, v144
v_mul_f32 v239, v145, v145
v_mul_f32 v240, v146, v146
v_mul_f32 v241, v147, v147
v_fma_f32 v238, v238, v237, v234
s_waitcnt lgkmcnt(6)
v_mfma_f32_32x32x16_bf16 v[176:191], v[132:135], v[20:23], v[176:191]
ds_read_b64_tr_b16 v[132:133], v1 offset:53248
ds_read_b64_tr_b16 v[134:135], v1 offset:54272
v_fma_f32 v239, v239, v237, v234
v_fma_f32 v240, v240, v237, v234
v_fma_f32 v241, v241, v237, v234
v_mul_f32 v238, v238, v144
v_mul_f32 v239, v239, v145
v_mul_f32 v240, v240, v146
s_waitcnt lgkmcnt(6)
v_mfma_f32_32x32x16_bf16 v[176:191], v[136:139], v[24:27], v[176:191]
ds_read_b64_tr_b16 v[136:137], v1 offset:57344
ds_read_b64_tr_b16 v[138:139], v1 offset:58368
v_mul_f32 v241, v241, v147
v_exp_f32 v238, v238
v_exp_f32 v239, v239
s_waitcnt lgkmcnt(6)
v_mfma_f32_32x32x16_bf16 v[176:191], v[140:143], v[28:31], v[176:191]
ds_read_b64_tr_b16 v[140:141], v1 offset:61440
ds_read_b64_tr_b16 v[142:143], v1 offset:62464
v_exp_f32 v240, v240
buffer_load_dwordx4 v[212:215], v194, s[32:35], s74 offen offset:2048 sc1
v_exp_f32 v241, v241
v_fma_f32 v238, v238, v235, v235
v_fma_f32 v239, v239, v235, v235
s_barrier
s_waitcnt lgkmcnt(6)
v_mfma_f32_32x32x16_bf16 v[176:191], v[128:131], v[32:35], v[176:191]
ds_read_b64_tr_b16 v[128:129], v2 offset:0
ds_read_b64_tr_b16 v[130:131], v2 offset:1024
v_fma_f32 v240, v240, v235, v235
v_fma_f32 v241, v241, v235, v235
v_rcp_f32 v238, v238
v_rcp_f32 v239, v239
s_waitcnt lgkmcnt(6)
v_mfma_f32_32x32x16_bf16 v[176:191], v[132:135], v[36:39], v[176:191]
ds_read_b64_tr_b16 v[132:133], v2 offset:4096
ds_read_b64_tr_b16 v[134:135], v2 offset:5120
v_rcp_f32 v240, v240
v_rcp_f32 v241, v241
v_mul_f32 v238, v238, v144
s_waitcnt lgkmcnt(6)
v_mfma_f32_32x32x16_bf16 v[176:191], v[136:139], v[40:43], v[176:191]
ds_read_b64_tr_b16 v[136:137], v2 offset:8192
ds_read_b64_tr_b16 v[138:139], v2 offset:9216
v_mul_f32 v239, v239, v145
v_mul_f32 v240, v240, v146
v_mul_f32 v241, v241, v147
v_cvt_pk_bf16_f32 v144, v238, v239
v_cvt_pk_bf16_f32 v145, v240, v241
s_waitcnt lgkmcnt(6)
v_mfma_f32_32x32x16_bf16 v[176:191], v[140:143], v[44:47], v[176:191]
ds_read_b64_tr_b16 v[140:141], v2 offset:12288
ds_read_b64_tr_b16 v[142:143], v2 offset:13312
v_mul_f32 v238, v148, v148
v_mul_f32 v239, v149, v149
v_mul_f32 v240, v150, v150
v_mul_f32 v241, v151, v151
v_fma_f32 v238, v238, v237, v234
s_barrier
s_waitcnt lgkmcnt(6)
v_mfma_f32_32x32x16_bf16 v[176:191], v[128:131], v[48:51], v[176:191]
ds_read_b64_tr_b16 v[128:129], v2 offset:16384
ds_read_b64_tr_b16 v[130:131], v2 offset:17408
v_fma_f32 v239, v239, v237, v234
v_fma_f32 v240, v240, v237, v234
v_fma_f32 v241, v241, v237, v234
v_mul_f32 v238, v238, v148
v_mul_f32 v239, v239, v149
v_mul_f32 v240, v240, v150
s_waitcnt lgkmcnt(6)
v_mfma_f32_32x32x16_bf16 v[176:191], v[132:135], v[52:55], v[176:191]
ds_read_b64_tr_b16 v[132:133], v2 offset:20480
ds_read_b64_tr_b16 v[134:135], v2 offset:21504
v_mul_f32 v241, v241, v151
v_exp_f32 v238, v238
v_exp_f32 v239, v239
s_waitcnt lgkmcnt(6)
v_mfma_f32_32x32x16_bf16 v[176:191], v[136:139], v[56:59], v[176:191]
ds_read_b64_tr_b16 v[136:137], v2 offset:24576
ds_read_b64_tr_b16 v[138:139], v2 offset:25600
v_exp_f32 v240, v240
s_waitcnt vmcnt(1)
v_xor_b32 v199, s89, v198
v_cmp_lt_u32 vcc, 15, v199
s_nop 0
s_cmp_lg_u64 vcc, 0
s_cbranch_scc1 RXCS
BXCS:
v_exp_f32 v241, v241
v_readlane_b32 s71, v198, s37
s_nop 0
s_cmp_eq_u32 s71, s45
s_cselect_b32 s39, 1, 0
v_fma_f32 v238, v238, v235, v235
v_fma_f32 v239, v239, v235, v235
s_waitcnt lgkmcnt(6)
v_mfma_f32_32x32x16_bf16 v[176:191], v[140:143], v[60:63], v[176:191]
ds_read_b64_tr_b16 v[140:141], v2 offset:28672
ds_read_b64_tr_b16 v[142:143], v2 offset:29696
v_fma_f32 v240, v240, v235, v235
v_fma_f32 v241, v241, v235, v235
v_rcp_f32 v238, v238
v_rcp_f32 v239, v239
s_barrier
s_waitcnt lgkmcnt(6)
v_mfma_f32_32x32x16_bf16 v[176:191], v[128:131], v[64:67], v[176:191]
ds_read_b64_tr_b16 v[128:129], v1 offset:0
ds_read_b64_tr_b16 v[130:131], v1 offset:1024
ds_read_b64_tr_b16 v[32:33], v1 offset:16384
ds_read_b64_tr_b16 v[34:35], v1 offset:17408
v_rcp_f32 v240, v240
v_rcp_f32 v241, v241
v_mul_f32 v238, v238, v148
s_waitcnt lgkmcnt(8)
v_mfma_f32_32x32x16_bf16 v[176:191], v[132:135], v[68:71], v[176:191]
PADS1:
s_cbranch_execz HOPB
ds_read_b64_tr_b16 v[132:133], v1 offset:4096
ds_read_b64_tr_b16 v[134:135], v1 offset:5120
ds_read_b64_tr_b16 v[36:37], v1 offset:20480
ds_read_b64_tr_b16 v[38:39], v1 offset:21504
v_mul_f32 v239, v239, v149
v_mul_f32 v240, v240, v150
v_mul_f32 v241, v241, v151
v_cvt_pk_bf16_f32 v146, v238, v239
v_cvt_pk_bf16_f32 v147, v240, v241
s_waitcnt lgkmcnt(10)
v_mfma_f32_32x32x16_bf16 v[176:191], v[136:139], v[72:75], v[176:191]
ds_read_b64_tr_b16 v[136:137], v1 offset:8192
ds_read_b64_tr_b16 v[138:139], v1 offset:9216
ds_read_b64_tr_b16 v[40:41], v1 offset:24576
ds_read_b64_tr_b16 v[42:43], v1 offset:25600
v_mul_f32 v238, v152, v152
v_mul_f32 v239, v153, v153
v_mul_f32 v240, v154, v154
v_mul_f32 v241, v155, v155
v_fma_f32 v238, v238, v237, v234
s_waitcnt lgkmcnt(12)
v_mfma_f32_32x32x16_bf16 v[176:191], v[140:143], v[76:79], v[176:191]
ds_read_b64_tr_b16 v[140:141], v1 offset:12288
ds_read_b64_tr_b16 v[142:143], v1 offset:13312
ds_read_b64_tr_b16 v[44:45], v1 offset:28672
ds_read_b64_tr_b16 v[46:47], v1 offset:29696
v_fma_f32 v239, v239, v237, v234
v_fma_f32 v240, v240, v237, v234
v_fma_f32 v241, v241, v237, v234
v_mul_f32 v238, v238, v152
v_mul_f32 v239, v239, v153
v_mul_f32 v240, v240, v154
s_barrier
s_waitcnt lgkmcnt(14)
v_mfma_f32_32x32x16_bf16 v[176:191], v[128:131], v[80:83], v[176:191]
v_mul_f32 v241, v241, v155
v_exp_f32 v238, v238
v_exp_f32 v239, v239
s_waitcnt lgkmcnt(10)
v_mfma_f32_32x32x16_bf16 v[176:191], v[132:135], v[84:87], v[176:191]
ds_write_b128 v4, v[144:147] offset:0
v_exp_f32 v240, v240
v_exp_f32 v241, v241
v_fma_f32 v238, v238, v235, v235
v_fma_f32 v239, v239, v235, v235
s_waitcnt lgkmcnt(7)
v_mfma_f32_32x32x16_bf16 v[176:191], v[136:139], v[88:91], v[176:191]
v_fma_f32 v240, v240, v235, v235
s_waitcnt vmcnt(0)
v_cmp_ne_u32 vcc, s89, v215
s_nop 0
s_cmp_lg_u64 vcc, 0
s_cbranch_scc1 RCS1S
BCS1S:
v_fma_f32 v241, v241, v235, v235
v_mov_b32 v215, 0
v_rcp_f32 v238, v238
v_rcp_f32 v239, v239
s_waitcnt lgkmcnt(3)
v_mfma_f32_32x32x16_bf16 v[176:191], v[140:143], v[92:95], v[176:191]
v_rcp_f32 v240, v240
v_rcp_f32 v241, v241
v_mul_f32 v238, v238, v152
s_barrier
v_mfma_f32_32x32x16_bf16 v[176:191], v[32:35], v[96:99], v[176:191]
ds_read_b64_tr_b16 v[128:129], v1 offset:32768
ds_read_b64_tr_b16 v[130:131], v1 offset:33792
v_mul_f32 v239, v239, v153
v_mul_f32 v240, v240, v154
v_mul_f32 v241, v241, v155
v_cvt_pk_bf16_f32 v152, v238, v239
v_cvt_pk_bf16_f32 v153, v240, v241
v_mfma_f32_32x32x16_bf16 v[176:191], v[36:39], v[100:103], v[176:191]
ds_read_b64_tr_b16 v[132:133], v1 offset:36864
ds_read_b64_tr_b16 v[134:135], v1 offset:37888
v_mul_f32 v238, v156, v156
v_mfma_f32_32x32x16_bf16 v[176:191], v[212:215], v[208:211], v[176:191]
v_mul_f32 v239, v157, v157
v_mul_f32 v240, v158, v158
v_mul_f32 v241, v159, v159
v_fma_f32 v238, v238, v237, v234
v_mfma_f32_32x32x16_bf16 v[176:191], v[40:43], v[104:107], v[176:191]
ds_read_b64_tr_b16 v[136:137], v1 offset:40960
ds_read_b64_tr_b16 v[138:139], v1 offset:41984
v_fma_f32 v239, v239, v237, v234
v_fma_f32 v240, v240, v237, v234
v_fma_f32 v241, v241, v237, v234
v_mul_f32 v238, v238, v156
v_mul_f32 v239, v239, v157
v_mul_f32 v240, v240, v158
s_waitcnt lgkmcnt(7)
v_mfma_f32_32x32x16_bf16 v[176:191], v[44:47], v[108:111], v[176:191]
ds_read_b64_tr_b16 v[140:141], v1 offset:45056
ds_read_b64_tr_b16 v[142:143], v1 offset:46080
v_mul_f32 v241, v241, v159
v_exp_f32 v238, v238
v_exp_f32 v239, v239
s_waitcnt lgkmcnt(8)
s_barrier
s_waitcnt lgkmcnt(6)
v_mfma_f32_32x32x16_bf16 v[176:191], v[128:131], v[112:115], v[176:191]
ds_read_b64_tr_b16 v[128:129], v1 offset:49152
ds_read_b64_tr_b16 v[130:131], v1 offset:50176
ds_read_b128 v[64:67], v3 offset:0
v_exp_f32 v240, v240
v_exp_f32 v241, v241
v_fma_f32 v238, v238, v235, v235
v_fma_f32 v239, v239, v235, v235
s_waitcnt lgkmcnt(7)
v_mfma_f32_32x32x16_bf16 v[176:191], v[132:135], v[116:119], v[176:191]
ds_read_b64_tr_b16 v[132:133], v1 offset:53248
ds_read_b64_tr_b16 v[134:135], v1 offset:54272
ds_read_b128 v[68:71], v3 offset:1024
v_fma_f32 v240, v240, v235, v235
v_fma_f32 v241, v241, v235, v235
v_rcp_f32 v238, v238
v_rcp_f32 v239, v239
s_waitcnt lgkmcnt(8)
v_mfma_f32_32x32x16_bf16 v[176:191], v[136:139], v[120:123], v[176:191]
ds_read_b64_tr_b16 v[136:137], v1 offset:57344
ds_read_b64_tr_b16 v[138:139], v1 offset:58368
ds_read_b128 v[72:75], v3 offset:2048
v_rcp_f32 v240, v240
v_rcp_f32 v241, v241
v_mul_f32 v238, v238, v156
s_waitcnt lgkmcnt(9)
v_mfma_f32_32x32x16_bf16 v[176:191], v[140:143], v[124:127], v[176:191]
ds_read_b64_tr_b16 v[140:141], v1 offset:61440
ds_read_b64_tr_b16 v[142:143], v1 offset:62464
ds_read_b128 v[76:79], v3 offset:3072
v_mul_f32 v239, v239, v157
v_mul_f32 v240, v240, v158
v_mul_f32 v241, v241, v159
v_cvt_pk_bf16_f32 v154, v238, v239
v_cvt_pk_bf16_f32 v155, v240, v241
s_barrier
s_waitcnt lgkmcnt(9)
v_mfma_f32_32x32x16_bf16 v[192:207], v[64:67], v[128:131], 0
ds_read_b64_tr_b16 v[128:129], v2 offset:0
ds_read_b64_tr_b16 v[130:131], v2 offset:1024
ds_read_b64_tr_b16 v[32:33], v2 offset:16384
ds_read_b64_tr_b16 v[34:35], v2 offset:17408
v_mul_f32 v238, v176, v176
v_lshlrev_b32 v216, 1, v247
v_mul_f32 v239, v177, v177
buffer_load_dwordx2 v[216:217], v216, s[32:35], s73 offen sc1
v_mul_f32 v240, v178, v178
v_mul_f32 v241, v179, v179
v_fma_f32 v238, v238, v237, v234
v_fma_f32 v239, v239, v237, v234
v_fma_f32 v240, v240, v237, v234
v_fma_f32 v241, v241, v237, v234
s_waitcnt lgkmcnt(10)
v_mfma_f32_32x32x16_bf16 v[192:207], v[68:71], v[132:135], v[192:207]
ds_read_b64_tr_b16 v[132:133], v2 offset:4096
ds_read_b64_tr_b16 v[134:135], v2 offset:5120
ds_read_b64_tr_b16 v[36:37], v2 offset:20480
ds_read_b64_tr_b16 v[38:39], v2 offset:21504
v_mul_f32 v238, v238, v176
v_mul_f32 v239, v239, v177
v_mul_f32 v240, v240, v178
v_mul_f32 v241, v241, v179
v_exp_f32 v238, v238
v_exp_f32 v239, v239
s_waitcnt lgkmcnt(11)
v_mfma_f32_32x32x16_bf16 v[192:207], v[72:75], v[136:139], v[192:207]
ds_read_b64_tr_b16 v[136:137], v2 offset:8192
ds_read_b64_tr_b16 v[138:139], v2 offset:9216
ds_read_b64_tr_b16 v[40:41], v2 offset:24576
ds_read_b64_tr_b16 v[42:43], v2 offset:25600
v_exp_f32 v240, v240
v_exp_f32 v241, v241
v_fma_f32 v238, v238, v235, v235
v_fma_f32 v239, v239, v235, v235
v_fma_f32 v240, v240, v235, v235
s_waitcnt lgkmcnt(12)
v_mfma_f32_32x32x16_bf16 v[192:207], v[76:79], v[140:143], v[192:207]
ds_read_b64_tr_b16 v[140:141], v2 offset:12288
ds_read_b64_tr_b16 v[142:143], v2 offset:13312
ds_read_b64_tr_b16 v[44:45], v2 offset:28672
ds_read_b64_tr_b16 v[46:47], v2 offset:29696
v_fma_f32 v241, v241, v235, v235
v_lshrrev_b32 v245, 5, v0
v_rcp_f32 v238, v238
v_lshlrev_b32 v245, 6, v245
v_rcp_f32 v239, v239
v_lshl_add_u32 v245, s86, 7, v245
v_rcp_f32 v240, v240
ds_read_b128 v[48:51], v245 offset:0
ds_read_b128 v[52:55], v245 offset:16
ds_read_b128 v[56:59], v245 offset:32
ds_read_b128 v[60:63], v245 offset:48
s_barrier
s_waitcnt lgkmcnt(15)
v_mfma_f32_32x32x16_bf16 v[80:95], v[64:67], v[128:131], 0
v_rcp_f32 v241, v241
v_mul_f32 v238, v238, v176
v_mul_f32 v239, v239, v177
v_mul_f32 v240, v240, v178
v_mul_f32 v241, v241, v179
v_cvt_pk_bf16_f32 v176, v238, v239
v_cvt_pk_bf16_f32 v177, v240, v241
s_waitcnt lgkmcnt(14)
v_mfma_f32_32x32x16_bf16 v[80:95], v[68:71], v[132:135], v[80:95]
ds_write_b128 v4, v[152:155] offset:4096
v_mul_f32 v238, v180, v180
v_mul_f32 v239, v181, v181
v_mul_f32 v240, v182, v182
v_mul_f32 v241, v183, v183
v_fma_f32 v238, v238, v237, v234
v_fma_f32 v239, v239, v237, v234
v_fma_f32 v240, v240, v237, v234
v_fma_f32 v241, v241, v237, v234
s_waitcnt lgkmcnt(11)
v_mfma_f32_32x32x16_bf16 v[80:95], v[72:75], v[136:139], v[80:95]
v_mul_f32 v238, v238, v180
v_mul_f32 v239, v239, v181
v_mul_f32 v240, v240, v182
v_mul_f32 v241, v241, v183
v_exp_f32 v238, v238
v_exp_f32 v239, v239
s_waitcnt lgkmcnt(7)
v_mfma_f32_32x32x16_bf16 v[80:95], v[76:79], v[140:143], v[80:95]
v_exp_f32 v240, v240
v_exp_f32 v241, v241
v_fma_f32 v238, v238, v235, v235
v_fma_f32 v239, v239, v235, v235
v_fma_f32 v240, v240, v235, v235
s_waitcnt lgkmcnt(0)
s_barrier
v_mfma_f32_32x32x16_bf16 v[112:127], v[64:67], v[32:35], 0
ds_read_b64_tr_b16 v[128:129], v1 offset:0
ds_read_b64_tr_b16 v[130:131], v1 offset:1024
ds_read_b64_tr_b16 v[32:33], v1 offset:16384
ds_read_b64_tr_b16 v[34:35], v1 offset:17408
ds_read_b128 v[96:99], v3 offset:4096
v_fma_f32 v241, v241, v235, v235
v_rcp_f32 v238, v238
v_rcp_f32 v239, v239
v_rcp_f32 v240, v240
v_mfma_f32_32x32x16_bf16 v[112:127], v[68:71], v[36:39], v[112:127]
ds_read_b64_tr_b16 v[132:133], v1 offset:4096
ds_read_b64_tr_b16 v[134:135], v1 offset:5120
ds_read_b64_tr_b16 v[36:37], v1 offset:20480
ds_read_b64_tr_b16 v[38:39], v1 offset:21504
ds_read_b128 v[100:103], v3 offset:5120
v_rcp_f32 v241, v241
v_mul_f32 v238, v238, v180
v_mul_f32 v239, v239, v181
v_mul_f32 v240, v240, v182
v_mul_f32 v241, v241, v183
v_cvt_pk_bf16_f32 v178, v238, v239
v_cvt_pk_bf16_f32 v179, v240, v241
v_mfma_f32_32x32x16_bf16 v[112:127], v[72:75], v[40:43], v[112:127]
ds_read_b64_tr_b16 v[136:137], v1 offset:8192
ds_read_b64_tr_b16 v[138:139], v1 offset:9216
ds_read_b64_tr_b16 v[40:41], v1 offset:24576
ds_read_b64_tr_b16 v[42:43], v1 offset:25600
ds_read_b128 v[104:107], v3 offset:6144
s_waitcnt vmcnt(0)
v_cmp_ne_u32 vcc, s89, v217
s_nop 0
s_cmp_lg_u64 vcc, 0
s_cbranch_scc1 RKS
BKS:
v_fma_f32 v244, v224, v216, v243
s_nop 1
v_fmac_f32_dpp v244, v216, v225 row_ror:8 row_mask:0xf bank_mask:0xf
v_fma_f32 v243, v11, v244, v242
s_nop 1
v_fmac_f32_dpp v243, v244, v12 row_ror:8 row_mask:0xf bank_mask:0xf
v_fma_f32 v160, v9, v244, v160
v_mfma_f32_32x32x16_bf16 v[112:127], v[76:79], v[44:47], v[112:127]
ds_read_b64_tr_b16 v[140:141], v1 offset:12288
ds_read_b64_tr_b16 v[142:143], v1 offset:13312
ds_read_b64_tr_b16 v[44:45], v1 offset:28672
ds_read_b64_tr_b16 v[46:47], v1 offset:29696
ds_read_b128 v[108:111], v3 offset:7168
v_fma_f32 v168, v9, v243, v168
v_fmac_f32_dpp v160, v244, v10 row_ror:8 row_mask:0xf bank_mask:0xf
s_nop 0
v_fmac_f32_dpp v168, v243, v10 row_ror:8 row_mask:0xf bank_mask:0xf
v_fma_f32 v161, v9, v160, v161
v_fma_f32 v169, v9, v168, v169
s_nop 0
v_fmac_f32_dpp v161, v160, v10 row_ror:8 row_mask:0xf bank_mask:0xf
v_fmac_f32_dpp v169, v168, v10 row_ror:8 row_mask:0xf bank_mask:0xf
s_barrier
s_waitcnt lgkmcnt(15)
v_mfma_f32_32x32x16_bf16 v[192:207], v[96:99], v[128:131], v[192:207]
v_fma_f32 v162, v9, v161, v162
v_fma_f32 v170, v9, v169, v170
s_nop 0
v_fmac_f32_dpp v162, v161, v10 row_ror:8 row_mask:0xf bank_mask:0xf
v_fmac_f32_dpp v170, v169, v10 row_ror:8 row_mask:0xf bank_mask:0xf
v_fma_f32 v163, v9, v162, v163
v_fma_f32 v171, v9, v170, v171
s_nop 0
v_fmac_f32_dpp v163, v162, v10 row_ror:8 row_mask:0xf bank_mask:0xf
s_waitcnt lgkmcnt(10)
v_mfma_f32_32x32x16_bf16 v[192:207], v[100:103], v[132:135], v[192:207]
ds_write_b128 v4, v[176:179] offset:16384
v_fmac_f32_dpp v171, v170, v10 row_ror:8 row_mask:0xf bank_mask:0xf
v_fma_f32 v164, v9, v163, v164
v_fma_f32 v172, v9, v171, v172
s_nop 0
v_fmac_f32_dpp v164, v163, v10 row_ror:8 row_mask:0xf bank_mask:0xf
v_fmac_f32_dpp v172, v171, v10 row_ror:8 row_mask:0xf bank_mask:0xf
v_mul_f32 v48, v160, v48
v_mul_f32 v49, v161, v49
s_waitcnt lgkmcnt(6)
v_mfma_f32_32x32x16_bf16 v[192:207], v[104:107], v[136:139], v[192:207]
v_mul_f32 v50, v162, v50
v_mul_f32 v51, v163, v51
v_cvt_pk_bf16_f32 v48, v48, v49
v_cvt_pk_bf16_f32 v49, v50, v51
v_mul_f32 v56, v168, v56
v_mul_f32 v57, v169, v57
v_mul_f32 v58, v170, v58
s_waitcnt lgkmcnt(1)
v_mfma_f32_32x32x16_bf16 v[192:207], v[108:111], v[140:143], v[192:207]
v_mul_f32 v59, v171, v59
v_cvt_pk_bf16_f32 v56, v56, v57
v_cvt_pk_bf16_f32 v57, v58, v59
v_fma_f32 v165, v9, v164, v165
v_fma_f32 v173, v9, v172, v173
s_nop 0
v_fmac_f32_dpp v165, v164, v10 row_ror:8 row_mask:0xf bank_mask:0xf
s_waitcnt lgkmcnt(0)
s_barrier
v_mfma_f32_32x32x16_bf16 v[80:95], v[96:99], v[32:35], v[80:95]
ds_read_b64_tr_b16 v[128:129], v1 offset:32768
ds_read_b64_tr_b16 v[130:131], v1 offset:33792
ds_read_b64_tr_b16 v[32:33], v1 offset:49152
ds_read_b64_tr_b16 v[34:35], v1 offset:50176
ds_read_b128 v[144:147], v3 offset:16384
v_fmac_f32_dpp v173, v172, v10 row_ror:8 row_mask:0xf bank_mask:0xf
v_fma_f32 v166, v9, v165, v166
v_fma_f32 v174, v9, v173, v174
s_nop 0
v_fmac_f32_dpp v166, v165, v10 row_ror:8 row_mask:0xf bank_mask:0xf
v_fmac_f32_dpp v174, v173, v10 row_ror:8 row_mask:0xf bank_mask:0xf
v_fma_f32 v167, v9, v166, v167
v_fma_f32 v175, v9, v174, v175
v_mfma_f32_32x32x16_bf16 v[80:95], v[100:103], v[36:39], v[80:95]
ds_read_b64_tr_b16 v[132:133], v1 offset:36864
ds_read_b64_tr_b16 v[134:135], v1 offset:37888
ds_read_b64_tr_b16 v[36:37], v1 offset:53248
ds_read_b64_tr_b16 v[38:39], v1 offset:54272
ds_read_b128 v[148:151], v3 offset:17408
v_fmac_f32_dpp v167, v166, v10 row_ror:8 row_mask:0xf bank_mask:0xf
v_fmac_f32_dpp v175, v174, v10 row_ror:8 row_mask:0xf bank_mask:0xf
v_mul_f32 v52, v164, v52
v_mul_f32 v53, v165, v53
v_mul_f32 v54, v166, v54
v_mul_f32 v55, v167, v55
v_cvt_pk_bf16_f32 v50, v52, v53
v_mfma_f32_32x32x16_bf16 v[80:95], v[104:107], v[40:43], v[80:95]
ds_read_b64_tr_b16 v[136:137], v1 offset:40960
ds_read_b64_tr_b16 v[138:139], v1 offset:41984
ds_read_b64_tr_b16 v[40:41], v1 offset:57344
ds_read_b64_tr_b16 v[42:43], v1 offset:58368
ds_read_b128 v[152:155], v3 offset:18432
v_cvt_pk_bf16_f32 v51, v54, v55
v_mul_f32 v60, v172, v60
v_mul_f32 v61, v173, v61
v_mul_f32 v62, v174, v62
v_mul_f32 v63, v175, v63
v_cvt_pk_bf16_f32 v58, v60, v61
v_cvt_pk_bf16_f32 v59, v62, v63
v_mfma_f32_32x32x16_bf16 v[80:95], v[108:111], v[44:47], v[80:95]
ds_read_b64_tr_b16 v[140:141], v1 offset:45056
ds_read_b64_tr_b16 v[142:143], v1 offset:46080
ds_read_b64_tr_b16 v[44:45], v1 offset:61440
ds_read_b64_tr_b16 v[46:47], v1 offset:62464
ds_read_b128 v[156:159], v3 offset:19456
v_mul_f32 v238, v184, v184
v_mul_f32 v239, v185, v185
v_mul_f32 v240, v186, v186
v_mul_f32 v241, v187, v187
v_fma_f32 v238, v238, v237, v234
v_fma_f32 v239, v239, v237, v234
v_fma_f32 v240, v240, v237, v234
v_fma_f32 v241, v241, v237, v234
s_barrier
s_waitcnt lgkmcnt(15)
v_mfma_f32_32x32x16_bf16 v[112:127], v[96:99], v[128:131], v[112:127]
v_mul_f32 v238, v238, v184
v_mul_f32 v239, v239, v185
v_mul_f32 v240, v240, v186
v_mul_f32 v241, v241, v187
v_exp_f32 v238, v238
v_exp_f32 v239, v239
s_waitcnt lgkmcnt(13)
v_mfma_f32_32x32x16_bf16 v[112:127], v[100:103], v[132:135], v[112:127]
ds_write_b128 v218, v[48:51]
v_exp_f32 v240, v240
v_exp_f32 v241, v241
v_fma_f32 v238, v238, v235, v235
v_fma_f32 v239, v239, v235, v235
v_fma_f32 v240, v240, v235, v235
v_fma_f32 v241, v241, v235, v235
v_rcp_f32 v238, v238
s_waitcnt lgkmcnt(9)
v_mfma_f32_32x32x16_bf16 v[112:127], v[104:107], v[136:139], v[112:127]
v_xor_b32 v218, 32, v218
ds_write_b128 v218, v[56:59]
v_rcp_f32 v239, v239
v_rcp_f32 v240, v240
v_rcp_f32 v241, v241
v_mul_f32 v238, v238, v184
v_mul_f32 v239, v239, v185
s_waitcnt lgkmcnt(5)
v_mfma_f32_32x32x16_bf16 v[112:127], v[108:111], v[140:143], v[112:127]
v_mul_f32 v240, v240, v186
v_mul_f32 v241, v241, v187
v_cvt_pk_bf16_f32 v184, v238, v239
v_cvt_pk_bf16_f32 v185, v240, v241
v_mul_f32 v238, v188, v188
v_mul_f32 v239, v189, v189
v_mul_f32 v240, v190, v190
v_mul_f32 v241, v191, v191
s_waitcnt lgkmcnt(0)
s_barrier
v_mfma_f32_32x32x16_bf16 v[192:207], v[144:147], v[32:35], v[192:207]
ds_read_b128 v[128:131], v252 offset:0
ds_read_b128 v[48:51], v252 offset:16384
v_fma_f32 v238, v238, v237, v234
ds_read_b64_tr_b16 v[16:17], v219 offset:0
ds_read_b64_tr_b16 v[32:33], v219 offset:4096
v_fma_f32 v239, v239, v237, v234
ds_read_b64_tr_b16 v[18:19], v220 offset:0
ds_read_b64_tr_b16 v[34:35], v220 offset:4096
v_fma_f32 v240, v240, v237, v234
v_fma_f32 v241, v241, v237, v234
v_mul_f32 v238, v238, v188
v_mul_f32 v239, v239, v189
v_mul_f32 v240, v240, v190
v_mul_f32 v241, v241, v191
v_mfma_f32_32x32x16_bf16 v[192:207], v[148:151], v[36:39], v[192:207]
ds_read_b128 v[132:135], v253 offset:0
ds_read_b128 v[52:55], v253 offset:16384
v_exp_f32 v238, v238
ds_read_b64_tr_b16 v[20:21], v219 offset:1024
ds_read_b64_tr_b16 v[36:37], v219 offset:5120
v_exp_f32 v239, v239
ds_read_b64_tr_b16 v[22:23], v220 offset:1024
ds_read_b64_tr_b16 v[38:39], v220 offset:5120
v_exp_f32 v240, v240
v_exp_f32 v241, v241
v_fma_f32 v238, v238, v235, v235
v_mfma_f32_32x32x16_bf16 v[192:207], v[152:155], v[40:43], v[192:207]
ds_read_b128 v[136:139], v254 offset:0
ds_read_b128 v[56:59], v254 offset:16384
v_fma_f32 v239, v239, v235, v235
ds_read_b64_tr_b16 v[24:25], v219 offset:2048
ds_read_b64_tr_b16 v[40:41], v219 offset:6144
v_fma_f32 v240, v240, v235, v235
ds_read_b64_tr_b16 v[26:27], v220 offset:2048
ds_read_b64_tr_b16 v[42:43], v220 offset:6144
v_fma_f32 v241, v241, v235, v235
v_rcp_f32 v238, v238
v_rcp_f32 v239, v239
v_rcp_f32 v240, v240
v_mfma_f32_32x32x16_bf16 v[192:207], v[156:159], v[44:47], v[192:207]
ds_read_b128 v[140:143], v255 offset:0
ds_read_b128 v[60:63], v255 offset:16384
v_rcp_f32 v241, v241
ds_read_b64_tr_b16 v[28:29], v219 offset:3072
ds_read_b64_tr_b16 v[44:45], v219 offset:7168
v_mul_f32 v238, v238, v188
ds_read_b64_tr_b16 v[30:31], v220 offset:3072
ds_read_b64_tr_b16 v[46:47], v220 offset:7168
v_mul_f32 v239, v239, v189
v_mul_f32 v240, v240, v190
v_mul_f32 v241, v241, v191
v_cvt_pk_bf16_f32 v186, v238, v239
v_cvt_pk_bf16_f32 v187, v240, v241
s_barrier
s_waitcnt lgkmcnt(15)
v_mfma_f32_32x32x16_bf16 v[192:207], v[16:19], v[128:131], v[192:207]
s_lshr_b32 s94, s85, 1
s_and_b32 s95, s85, 1
v_lshrrev_b32 v216, 5, v0
v_and_b32 v11, 31, v0
v_lshl_add_u32 v216, v216, 1, s94
s_waitcnt lgkmcnt(13)
v_mfma_f32_32x32x16_bf16 v[192:207], v[20:23], v[132:135], v[192:207]
ds_write_b128 v4, v[184:187] offset:20480
v_lshl_add_u32 v11, s95, 5, v11
v_lshl_add_u32 v14, s94, 10, v221
v_lshl_add_u32 v11, s88, 6, v11
s_movk_i32 s95, 7168
v_lshlrev_b32 v11, 1, v11
s_waitcnt lgkmcnt(8)
v_mfma_f32_32x32x16_bf16 v[192:207], v[24:27], v[136:139], v[192:207]
v_mad_u32_u24 v13, v216, s95, v11
v_lshlrev_b32 v216, 5, v216
v_lshlrev_b32 v13, 1, v13
v_lshl_add_u32 v216, s86, 7, v216
s_waitcnt lgkmcnt(2)
v_mfma_f32_32x32x16_bf16 v[192:207], v[28:31], v[140:143], v[192:207]
global_load_ushort v12, v11, s[46:47]
global_load_ushort v11, v11, s[42:43]
s_waitcnt lgkmcnt(0)
s_barrier
v_mfma_f32_32x32x16_bf16 v[192:207], v[32:35], v[48:51], v[192:207]
ds_read_b64_tr_b16 v[128:129], v1 offset:0
ds_read_b64_tr_b16 v[130:131], v1 offset:1024
ds_read_b128 v[64:67], v3 offset:20480
s_mul_i32 s60, s87, 42
v_lshrrev_b32 v222, 4, v221
s_lshr_b32 s94, s85, 1
v_lshrrev_b32 v208, 4, v0
v_mfma_f32_32x32x16_bf16 v[192:207], v[36:39], v[52:55], v[192:207]
ds_read_b64_tr_b16 v[132:133], v1 offset:4096
ds_read_b64_tr_b16 v[134:135], v1 offset:5120
ds_read_b128 v[68:71], v3 offset:21504
s_add_u32 s60, s60, s94
v_and_b32 v222, 0x180, v222
s_mul_i32 s60, s60, 8704
v_mfma_f32_32x32x16_bf16 v[192:207], v[40:43], v[56:59], v[192:207]
ds_read_b64_tr_b16 v[136:137], v1 offset:8192
ds_read_b64_tr_b16 v[138:139], v1 offset:9216
ds_read_b128 v[72:75], v3 offset:22528
v_and_b32 v215, 3, v0
s_and_b32 s71, s2, 7
v_lshl_add_u32 v222, v208, 4, v222
v_mfma_f32_32x32x16_bf16 v[192:207], v[44:47], v[60:63], v[192:207]
ds_read_b64_tr_b16 v[140:141], v1 offset:12288
ds_read_b64_tr_b16 v[142:143], v1 offset:13312
ds_read_b128 v[76:79], v3 offset:23552
s_mul_i32 s71, s71, 52224
v_and_b32 v208, 4, v0
s_add_u32 s60, s60, 1048576
v_lshl_add_u32 v222, v215, 2, v222
s_barrier
s_waitcnt lgkmcnt(9)
v_mfma_f32_32x32x16_bf16 v[192:207], v[64:67], v[128:131], v[192:207]
ds_read_b64_tr_b16 v[128:129], v1 offset:16384
ds_read_b64_tr_b16 v[130:131], v1 offset:17408
s_add_u32 s59, s60, s71
v_mul_u32_u24 v215, 2176, v208
s_mul_i32 s99, s37, 52224
s_waitcnt lgkmcnt(8)
v_mfma_f32_32x32x16_bf16 v[192:207], v[68:71], v[132:135], v[192:207]
ds_read_b64_tr_b16 v[132:133], v1 offset:20480
ds_read_b64_tr_b16 v[134:135], v1 offset:21504
v_add_u32 v222, 8192, v222
s_add_u32 s99, s99, s60
v_lshl_add_u32 v208, v208, 4, v222
s_waitcnt lgkmcnt(7)
v_mfma_f32_32x32x16_bf16 v[192:207], v[72:75], v[136:139], v[192:207]
ds_read_b64_tr_b16 v[136:137], v1 offset:24576
ds_read_b64_tr_b16 v[138:139], v1 offset:25600
s_bfe_u32 s71, s2, 0x30008
v_add_u32 v222, v215, v222
s_mul_i32 s71, s71, 52224
v_bfe_u32 v215, v0, 3, 1
s_waitcnt lgkmcnt(6)
v_mfma_f32_32x32x16_bf16 v[192:207], v[76:79], v[140:143], v[192:207]
ds_read_b64_tr_b16 v[140:141], v1 offset:28672
ds_read_b64_tr_b16 v[142:143], v1 offset:29696
s_add_u32 s60, s60, 17408
v_lshl_add_u32 v208, v215, 31, v208
s_add_u32 s60, s60, s71
s_add_u32 s99, s99, 34816
s_barrier
s_waitcnt lgkmcnt(6)
v_mfma_f32_32x32x16_bf16 v[80:95], v[144:147], v[128:131], v[80:95]
ds_read_b128 v[128:131], v248 offset:32768
s_waitcnt lgkmcnt(5)
v_mfma_f32_32x32x16_bf16 v[80:95], v[148:151], v[132:135], v[80:95]
ds_read_b128 v[132:135], v249 offset:32768
v_cvt_pk_bf16_f32 v192, v192, v193
v_cvt_pk_bf16_f32 v193, v194, v195
v_cvt_pk_bf16_f32 v194, v196, v197
v_cvt_pk_bf16_f32 v195, v198, v199
v_cvt_pk_bf16_f32 v196, v200, v201
s_waitcnt lgkmcnt(4)
v_mfma_f32_32x32x16_bf16 v[80:95], v[152:155], v[136:139], v[80:95]
ds_read_b128 v[136:139], v250 offset:32768
v_add3_u32 v212, v192, v193, v194
v_cvt_pk_bf16_f32 v197, v202, v203
v_add3_u32 v212, v212, v195, s89
v_cvt_pk_bf16_f32 v198, v204, v205
v_cvt_pk_bf16_f32 v199, v206, v207
buffer_store_dwordx4 v[192:195], v221, s[32:35], s59 offen offset:0 sc1
s_waitcnt lgkmcnt(3)
v_mfma_f32_32x32x16_bf16 v[80:95], v[156:159], v[140:143], v[80:95]
ds_read_b128 v[140:143], v251 offset:32768
v_add3_u32 v213, v196, v197, v198
v_add_u32_dpp v212, v212, v212 row_ror:4 row_mask:0xf bank_mask:0x5
v_add3_u32 v213, v213, v199, s89
s_nop 1
v_add_u32_dpp v212, v213, v213 row_ror:4 row_mask:0xf bank_mask:0xa
s_nop 1
v_add_u32_dpp v212, v212, v212 row_ror:8 row_mask:0xf bank_mask:0xf
buffer_store_dwordx4 v[196:199], v221, s[32:35], s59 offen offset:1024 sc1
buffer_store_dword v212, v208, s[32:35], s59 offen sc1
s_barrier
s_waitcnt lgkmcnt(3)
v_mfma_f32_32x32x16_bf16 v[80:95], v[16:19], v[128:131], v[80:95]
ds_read_b128 v[128:131], v248 offset:49152
s_lshl_b32 s71, s87, 1
ds_read_b128 v[176:179], v216 offset:0
v_lshlrev_b32 v160, 16, v230
v_lshrrev_b32 v214, 3, v0
ds_read_b128 v[180:183], v216 offset:16
v_and_b32 v161, 0xffff0000, v230
v_lshlrev_b32 v162, 16, v231
v_and_b32 v163, 0xffff0000, v231
s_waitcnt lgkmcnt(5)
v_mfma_f32_32x32x16_bf16 v[80:95], v[20:23], v[132:135], v[80:95]
ds_read_b128 v[132:135], v249 offset:49152
s_add_u32 s71, s71, s86
v_lshlrev_b32 v164, 16, v232
v_and_b32 v165, 0xffff0000, v232
v_lshlrev_b32 v166, 16, v233
s_waitcnt lgkmcnt(5)
v_mfma_f32_32x32x16_bf16 v[80:95], v[24:27], v[136:139], v[80:95]
ds_read_b128 v[136:139], v250 offset:49152
v_and_b32 v215, 7, v0
v_and_b32 v167, 0xffff0000, v233
s_mul_i32 s38, s71, 57344
s_waitcnt vmcnt(4)
v_lshlrev_b32 v12, 16, v12
s_waitcnt vmcnt(3)
v_lshlrev_b32 v11, 16, v11
v_fma_f32 v160, v160, v11, -v12
s_waitcnt lgkmcnt(5)
v_mfma_f32_32x32x16_bf16 v[80:95], v[28:31], v[140:143], v[80:95]
ds_read_b128 v[140:143], v251 offset:49152
v_mul_u32_u24 v214, 1792, v214
v_fma_f32 v161, v161, v11, -v12
v_fma_f32 v162, v162, v11, -v12
v_fma_f32 v163, v163, v11, -v12
v_fma_f32 v164, v164, v11, -v12
s_barrier
s_waitcnt lgkmcnt(5)
v_mfma_f32_32x32x16_bf16 v[80:95], v[32:35], v[128:131], v[80:95]
ds_read_b64_tr_b16 v[128:129], v2 offset:0
ds_read_b64_tr_b16 v[130:131], v2 offset:1024
s_lshr_b32 s94, s85, 1
v_fma_f32 v165, v165, v11, -v12
PADS2:
s_cbranch_execz HOPB
v_lshl_add_u32 v214, v215, 4, v214
v_fma_f32 v166, v166, v11, -v12
v_fma_f32 v167, v167, v11, -v12
s_waitcnt lgkmcnt(6)
v_fma_f32 v160, v160, v176, v12
s_waitcnt lgkmcnt(4)
v_mfma_f32_32x32x16_bf16 v[80:95], v[36:39], v[132:135], v[80:95]
ds_read_b64_tr_b16 v[132:133], v2 offset:4096
ds_read_b64_tr_b16 v[134:135], v2 offset:5120
s_mul_i32 s71, s94, 28672
v_fma_f32 v161, v161, v177, v12
s_add_u32 s61, s38, s71
v_fma_f32 v162, v162, v178, v12
v_fma_f32 v163, v163, v179, v12
s_waitcnt lgkmcnt(5)
v_mfma_f32_32x32x16_bf16 v[80:95], v[40:43], v[136:139], v[80:95]
ds_read_b64_tr_b16 v[136:137], v2 offset:8192
ds_read_b64_tr_b16 v[138:139], v2 offset:9216
s_lshl_b32 s71, s37, 1
v_fma_f32 v164, v164, v180, v12
s_and_b32 s95, s85, 1
v_fma_f32 v165, v165, v181, v12
s_add_u32 s71, s71, s95
v_fma_f32 v166, v166, v182, v12
v_fma_f32 v167, v167, v183, v12
s_waitcnt lgkmcnt(6)
v_mfma_f32_32x32x16_bf16 v[80:95], v[44:47], v[140:143], v[80:95]
ds_read_b64_tr_b16 v[140:141], v2 offset:12288
ds_read_b64_tr_b16 v[142:143], v2 offset:13312
s_lshl_b32 s71, s71, 7
v_mov_b64 v[168:169], 0
s_add_u32 s61, s61, s71
v_mov_b64 v[170:171], 0
s_mov_b32 s78, 3670016
v_mov_b64 v[172:173], 0
s_mov_b32 s79, 0x20000
v_mov_b64 v[174:175], 0
s_barrier
s_waitcnt lgkmcnt(6)
v_mfma_f32_32x32x16_bf16 v[80:95], v[64:67], v[128:131], v[80:95]
ds_read_b64_tr_b16 v[128:129], v2 offset:16384
ds_read_b64_tr_b16 v[130:131], v2 offset:17408
s_mul_i32 s71, s87, 7
s_add_u32 s71, s71, s88
s_mul_i32 s71, s71, 52224
s_add_u32 s8, s71, 1048576
s_add_u32 s9, s8, 8704
s_waitcnt lgkmcnt(6)
v_mfma_f32_32x32x16_bf16 v[80:95], v[68:71], v[132:135], v[80:95]
ds_read_b64_tr_b16 v[132:133], v2 offset:20480
ds_read_b64_tr_b16 v[134:135], v2 offset:21504
s_add_u32 s10, s8, 17408
s_add_u32 s11, s8, 26112
s_add_u32 s44, s8, 34816
s_lshl_b32 s98, s89, 1
s_lshr_b32 s94, s85, 1
s_mul_i32 s71, s94, 14336
s_waitcnt lgkmcnt(6)
v_mfma_f32_32x32x16_bf16 v[80:95], v[72:75], v[136:139], v[80:95]
ds_read_b64_tr_b16 v[136:137], v2 offset:24576
ds_read_b64_tr_b16 v[138:139], v2 offset:25600
s_add_u32 s12, s38, s71
s_lshl_b32 s71, s88, 1
s_and_b32 s95, s85, 1
s_add_u32 s71, s71, s95
s_lshl_b32 s71, s71, 7
s_waitcnt lgkmcnt(6)
v_mfma_f32_32x32x16_bf16 v[80:95], v[76:79], v[140:143], v[80:95]
ds_read_b64_tr_b16 v[140:141], v2 offset:28672
ds_read_b64_tr_b16 v[142:143], v2 offset:29696
s_add_u32 s12, s12, s71
s_add_u32 s13, s12, 28672
v_lshl_add_u32 v222, s94, 6, v222
s_barrier
s_waitcnt lgkmcnt(6)
v_mfma_f32_32x32x16_bf16 v[112:127], v[144:147], v[128:131], v[112:127]
ds_read_b128 v[128:131], v248 offset:0
s_waitcnt lgkmcnt(5)
v_mfma_f32_32x32x16_bf16 v[112:127], v[148:151], v[132:135], v[112:127]
ds_read_b128 v[132:135], v249 offset:0
v_cvt_pk_bf16_f32 v80, v80, v81
v_cvt_pk_bf16_f32 v81, v82, v83
v_cvt_pk_bf16_f32 v82, v84, v85
v_cvt_pk_bf16_f32 v83, v86, v87
v_cvt_pk_bf16_f32 v84, v88, v89
s_waitcnt lgkmcnt(4)
v_mfma_f32_32x32x16_bf16 v[112:127], v[152:155], v[136:139], v[112:127]
ds_read_b128 v[136:139], v250 offset:0
v_add3_u32 v212, v80, v81, v82
v_cvt_pk_bf16_f32 v85, v90, v91
v_add3_u32 v212, v212, v83, s89
v_cvt_pk_bf16_f32 v86, v92, v93
v_cvt_pk_bf16_f32 v87, v94, v95
buffer_store_dwordx4 v[80:83], v221, s[32:35], s60 offen offset:0 sc1
s_waitcnt lgkmcnt(3)
v_mfma_f32_32x32x16_bf16 v[112:127], v[156:159], v[140:143], v[112:127]
ds_read_b128 v[140:143], v251 offset:0
v_add3_u32 v213, v84, v85, v86
v_add_u32_dpp v212, v212, v212 row_ror:4 row_mask:0xf bank_mask:0x5
v_add3_u32 v213, v213, v87, s89
s_nop 1
v_add_u32_dpp v212, v213, v213 row_ror:4 row_mask:0xf bank_mask:0xa
s_nop 1
v_add_u32_dpp v212, v212, v212 row_ror:8 row_mask:0xf bank_mask:0xf
buffer_store_dwordx4 v[84:87], v221, s[32:35], s60 offen offset:1024 sc1
buffer_store_dword v212, v208, s[32:35], s60 offen sc1
s_barrier
s_waitcnt lgkmcnt(3)
v_mfma_f32_32x32x16_bf16 v[112:127], v[16:19], v[128:131], v[112:127]
ds_read_b128 v[128:131], v248 offset:16384
v_and_b32 v234, 1, v0
v_lshrrev_b32 v235, 3, v0
s_waitcnt lgkmcnt(3)
v_mfma_f32_32x32x16_bf16 v[112:127], v[20:23], v[132:135], v[112:127]
ds_read_b128 v[132:135], v249 offset:16384
v_lshlrev_b32 v234, 4, v234
v_xor_b32 v235, v235, v0
v_mov_b32 v215, 0x3f80
s_waitcnt lgkmcnt(3)
v_mfma_f32_32x32x16_bf16 v[112:127], v[24:27], v[136:139], v[112:127]
ds_read_b128 v[136:139], v250 offset:16384
v_and_b32 v235, 4, v235
v_lshlrev_b32 v215, v234, v215
s_waitcnt lgkmcnt(3)
v_mfma_f32_32x32x16_bf16 v[112:127], v[28:31], v[140:143], v[112:127]
ds_read_b128 v[140:143], v251 offset:16384
v_bfe_u32 v234, v0, 3, 2
v_bfe_u32 v223, v0, 1, 1
s_barrier
s_waitcnt lgkmcnt(3)
v_mfma_f32_32x32x16_bf16 v[112:127], v[32:35], v[128:131], v[112:127]
ds_read_b64_tr_b16 v[128:129], v1 offset:32768
ds_read_b64_tr_b16 v[130:131], v1 offset:33792
s_lshr_b32 s2, s85, 1
v_lshl_add_u32 v235, v235, 1, v223
v_lshl_add_u32 v3, s2, 14, v3
v_lshl_add_u32 v223, v234, 1, v235
s_waitcnt lgkmcnt(4)
v_mfma_f32_32x32x16_bf16 v[112:127], v[36:39], v[132:135], v[112:127]
ds_read_b64_tr_b16 v[132:133], v1 offset:36864
ds_read_b64_tr_b16 v[134:135], v1 offset:37888
v_lshl_add_u32 v219, s2, 12, v219
v_cmp_eq_u32 vcc, 0, v223
s_nop 1
v_cndmask_b32 v234, 0, v215, vcc
v_lshl_add_u32 v220, s2, 12, v220
v_cmp_eq_u32 vcc, 1, v223
s_nop 1
v_cndmask_b32 v235, 0, v215, vcc
s_waitcnt lgkmcnt(5)
v_mfma_f32_32x32x16_bf16 v[112:127], v[40:43], v[136:139], v[112:127]
ds_read_b64_tr_b16 v[136:137], v1 offset:40960
ds_read_b64_tr_b16 v[138:139], v1 offset:41984
s_lshl_b32 s2, s2, 5
v_cmp_eq_u32 vcc, 2, v223
s_nop 1
v_cndmask_b32 v236, 0, v215, vcc
v_xor_b32 v219, s2, v219
v_xor_b32 v220, s2, v220
s_waitcnt lgkmcnt(6)
v_mfma_f32_32x32x16_bf16 v[112:127], v[44:47], v[140:143], v[112:127]
ds_read_b64_tr_b16 v[140:141], v1 offset:45056
ds_read_b64_tr_b16 v[142:143], v1 offset:46080
s_lshl_b32 s2, s2, 3
v_cmp_eq_u32 vcc, 3, v223
s_nop 1
v_cndmask_b32 v237, 0, v215, vcc
v_xor_b32 v3, s2, v3
s_barrier
s_waitcnt lgkmcnt(6)
v_mfma_f32_32x32x16_bf16 v[112:127], v[64:67], v[128:131], v[112:127]
ds_read_b64_tr_b16 v[128:129], v1 offset:49152
ds_read_b64_tr_b16 v[130:131], v1 offset:50176
ds_read_b128 v[16:19], v3 offset:0
buffer_load_dwordx4 v[176:179], v14, s[32:35], s8 offen sc1
buffer_load_dwordx4 v[180:183], v14, s[32:35], s9 offen sc1
buffer_load_dword v238, v222, s[32:35], s8 offen sc1
s_waitcnt lgkmcnt(7)
v_mfma_f32_32x32x16_bf16 v[112:127], v[68:71], v[132:135], v[112:127]
ds_read_b64_tr_b16 v[132:133], v1 offset:53248
ds_read_b64_tr_b16 v[134:135], v1 offset:54272
ds_read_b128 v[20:23], v3 offset:1024
s_lshl_b32 s94, s84, 11
s_add_u32 s94, s94, 8192
v_lshl_add_u32 v210, v0, 4, s94
v_xor_b32 v211, 4096, v210
s_waitcnt lgkmcnt(8)
v_mfma_f32_32x32x16_bf16 v[112:127], v[72:75], v[136:139], v[112:127]
ds_read_b64_tr_b16 v[136:137], v1 offset:57344
ds_read_b64_tr_b16 v[138:139], v1 offset:58368
ds_read_b128 v[24:27], v3 offset:2048
s_waitcnt lgkmcnt(9)
v_mfma_f32_32x32x16_bf16 v[112:127], v[76:79], v[140:143], v[112:127]
ds_read_b64_tr_b16 v[140:141], v1 offset:61440
ds_read_b64_tr_b16 v[142:143], v1 offset:62464
ds_read_b128 v[28:31], v3 offset:3072
s_barrier
s_waitcnt lgkmcnt(9)
v_mfma_f32_32x32x16_bf16 v[160:175], v[16:19], v[128:131], v[160:175]
ds_read_b64_tr_b16 v[128:129], v2 offset:0
ds_read_b64_tr_b16 v[130:131], v2 offset:1024
ds_read_b128 v[32:35], v3 offset:4096
s_add_u32 s71, s61, 14336
s_nop 1
v_cvt_pk_bf16_f32 v112, v112, v113
v_cvt_pk_bf16_f32 v113, v114, v115
v_cvt_pk_bf16_f32 v114, v116, v117
v_cvt_pk_bf16_f32 v115, v118, v119
v_cvt_pk_bf16_f32 v116, v120, v121
s_cmp_eq_u32 s39, 0
s_cbranch_scc1 SA4
buffer_store_dwordx4 v[112:115], v214, s[76:79], s61 offen
SB4:
s_waitcnt lgkmcnt(9)
v_mfma_f32_32x32x16_bf16 v[160:175], v[20:23], v[132:135], v[160:175]
ds_read_b64_tr_b16 v[132:133], v2 offset:4096
ds_read_b64_tr_b16 v[134:135], v2 offset:5120
ds_read_b128 v[36:39], v3 offset:5120
v_add3_u32 v212, v112, v113, v114
v_cvt_pk_bf16_f32 v117, v122, v123
v_add3_u32 v212, v212, v115, s89
v_cvt_pk_bf16_f32 v118, v124, v125
v_cvt_pk_bf16_f32 v119, v126, v127
s_waitcnt lgkmcnt(9)
v_mfma_f32_32x32x16_bf16 v[160:175], v[24:27], v[136:139], v[160:175]
ds_read_b64_tr_b16 v[136:137], v2 offset:8192
ds_read_b64_tr_b16 v[138:139], v2 offset:9216
ds_read_b128 v[40:43], v3 offset:6144
v_add3_u32 v213, v116, v117, v118
v_add_u32_dpp v212, v212, v212 row_ror:4 row_mask:0xf bank_mask:0x5
v_add3_u32 v213, v213, v119, s89
s_nop 1
v_add_u32_dpp v212, v213, v213 row_ror:4 row_mask:0xf bank_mask:0xa
s_nop 1
v_add_u32_dpp v212, v212, v212 row_ror:8 row_mask:0xf bank_mask:0xf
s_cmp_eq_u32 s39, 0
s_cbranch_scc1 SA5
buffer_store_dwordx4 v[116:119], v214, s[76:79], s71 offen
SB5:
s_waitcnt lgkmcnt(9)
v_mfma_f32_32x32x16_bf16 v[160:175], v[28:31], v[140:143], v[160:175]
ds_read_b64_tr_b16 v[140:141], v2 offset:12288
ds_read_b64_tr_b16 v[142:143], v2 offset:13312
ds_read_b128 v[44:47], v3 offset:7168
s_cmp_eq_u32 s39, 0
s_cbranch_scc1 SA6
buffer_store_dword v212, v208, s[32:35], s99 offen
SB6:
s_barrier
s_waitcnt lgkmcnt(9)
v_mfma_f32_32x32x16_bf16 v[160:175], v[32:35], v[128:131], v[160:175]
ds_read_b128 v[128:131], v252 offset:16384
ds_read_b64_tr_b16 v[48:49], v219 offset:0
ds_read_b64_tr_b16 v[50:51], v220 offset:0
s_waitcnt lgkmcnt(9)
v_mfma_f32_32x32x16_bf16 v[160:175], v[36:39], v[132:135], v[160:175]
ds_read_b128 v[132:135], v253 offset:16384
ds_read_b64_tr_b16 v[52:53], v219 offset:1024
ds_read_b64_tr_b16 v[54:55], v220 offset:1024
s_waitcnt lgkmcnt(9)
v_mfma_f32_32x32x16_bf16 v[160:175], v[40:43], v[136:139], v[160:175]
ds_read_b128 v[136:139], v254 offset:16384
ds_read_b64_tr_b16 v[56:57], v219 offset:2048
ds_read_b64_tr_b16 v[58:59], v220 offset:2048
s_waitcnt lgkmcnt(9)
v_mfma_f32_32x32x16_bf16 v[160:175], v[44:47], v[140:143], v[160:175]
ds_read_b128 v[140:143], v255 offset:16384
ds_read_b64_tr_b16 v[60:61], v219 offset:3072
ds_read_b64_tr_b16 v[62:63], v220 offset:3072
s_barrier
s_waitcnt lgkmcnt(9)
v_mfma_f32_32x32x16_bf16 v[160:175], v[48:51], v[128:131], v[160:175]
buffer_load_dwordx4 v[184:187], v14, s[32:35], s10 offen sc1
s_waitcnt vmcnt(6)
v_add3_u32 v223, v176, v177, v178
s_waitcnt vmcnt(5)
v_add3_u32 v215, v180, v181, v182
v_add3_u32 v223, v223, v179, s98
v_add3_u32 v223, v223, v215, v183
s_waitcnt vmcnt(4)
v_add_u32_dpp v215, v238, v238 row_ror:4 row_mask:0xf bank_mask:0xf
v_add_u32_dpp v223, v223, v223 row_ror:4 row_mask:0xf bank_mask:0xf
s_nop 1
v_add_u32_dpp v223, v223, v223 row_ror:8 row_mask:0xf bank_mask:0xf
v_cmp_ne_u32 vcc, v223, v215
s_nop 0
s_cmp_lg_u64 vcc, 0
s_cbranch_scc1 RG0S
BG0S:
buffer_load_dwordx4 v[188:191], v14, s[32:35], s11 offen sc1
buffer_load_dword v239, v222, s[32:35], s10 offen sc1
s_waitcnt lgkmcnt(6)
v_mfma_f32_32x32x16_bf16 v[160:175], v[52:55], v[132:135], v[160:175]
v_mfma_f32_32x32x16_bf16 v[160:175], v[234:237], v[176:179], v[160:175]
s_waitcnt lgkmcnt(3)
v_mfma_f32_32x32x16_bf16 v[160:175], v[56:59], v[136:139], v[160:175]
v_mfma_f32_32x32x16_bf16 v[160:175], v[234:237], v[180:183], v[160:175]
s_waitcnt lgkmcnt(0)
v_mfma_f32_32x32x16_bf16 v[160:175], v[60:63], v[140:143], v[160:175]
TAIL:
buffer_load_dwordx4 v[144:147], v214, s[76:79], s12 offen sc1
buffer_load_dwordx4 v[148:151], v214, s[76:79], s13 offen sc1
buffer_load_dword v240, v222, s[32:35], s44 offen sc1
s_nop 7
s_nop 3
ds_write_b128 v210, v[168:171]
ds_write_b128 v210, v[172:175] offset:1024
s_waitcnt lgkmcnt(0)
s_barrier
ds_read_b128 v[152:155], v211
ds_read_b128 v[156:159], v211 offset:1024
s_waitcnt vmcnt(5)
v_add3_u32 v223, v184, v185, v186
s_waitcnt vmcnt(4)
v_add3_u32 v215, v188, v189, v190
v_add3_u32 v223, v223, v187, s98
v_add3_u32 v223, v223, v215, v191
s_waitcnt vmcnt(3)
v_add_u32_dpp v215, v239, v239 row_ror:4 row_mask:0xf bank_mask:0xf
v_add_u32_dpp v223, v223, v223 row_ror:4 row_mask:0xf bank_mask:0xf
s_nop 1
v_add_u32_dpp v223, v223, v223 row_ror:8 row_mask:0xf bank_mask:0xf
v_cmp_ne_u32 vcc, v223, v215
s_nop 0
s_cmp_lg_u64 vcc, 0
s_cbranch_scc1 RG1
BG1:
v_mfma_f32_32x32x16_bf16 v[160:175], v[234:237], v[184:187], v[160:175]
v_mfma_f32_32x32x16_bf16 v[160:175], v[234:237], v[188:191], v[160:175]
s_waitcnt vmcnt(2)
v_add3_u32 v223, v144, v145, v146
s_waitcnt vmcnt(1)
v_add3_u32 v215, v148, v149, v150
v_add3_u32 v223, v223, v147, s98
v_add3_u32 v223, v223, v215, v151
s_waitcnt vmcnt(0)
v_add_u32_dpp v215, v240, v240 row_ror:4 row_mask:0xf bank_mask:0xf
v_add_u32_dpp v223, v223, v223 row_ror:4 row_mask:0xf bank_mask:0xf
s_nop 1
v_add_u32_dpp v223, v223, v223 row_ror:8 row_mask:0xf bank_mask:0xf
v_cmp_ne_u32 vcc, v223, v215
s_nop 0
s_cmp_lg_u64 vcc, 0
s_cbranch_scc1 RG2
BG2:
v_mfma_f32_32x32x16_bf16 v[160:175], v[234:237], v[144:147], v[160:175]
v_mfma_f32_32x32x16_bf16 v[160:175], v[234:237], v[148:151], v[160:175]
s_waitcnt lgkmcnt(1)
s_nop 10
v_add_f32 v160, v160, v152
v_add_f32 v161, v161, v153
buffer_store_dword v160, v13, s[76:79], s38 offen offset:0
v_add_f32 v162, v162, v154
buffer_store_dword v161, v13, s[76:79], s38 offen offset:1792
s_add_u32 s38, s38, 3584
v_add_f32 v163, v163, v155
buffer_store_dword v162, v13, s[76:79], s38 offen offset:0
s_waitcnt lgkmcnt(0)
v_add_f32 v164, v164, v156
buffer_store_dword v163, v13, s[76:79], s38 offen offset:1792
s_add_u32 s38, s38, 3584
v_add_f32 v165, v165, v157
buffer_store_dword v164, v13, s[76:79], s38 offen offset:0
v_add_f32 v166, v166, v158
buffer_store_dword v165, v13, s[76:79], s38 offen offset:1792
s_add_u32 s38, s38, 3584
v_add_f32 v167, v167, v159
buffer_store_dword v166, v13, s[76:79], s38 offen offset:0
buffer_store_dword v167, v13, s[76:79], s38 offen offset:1792
s_cmp_lg_u32 s87, 31
s_cselect_b32 s94, 1, s88
s_or_b32 s94, s94, s84
s_cmp_lg_u32 s94, 0
s_cbranch_scc1 TNE
v_mov_b32 v209, s89
v_lshlrev_b32 v210, 2, v0
buffer_store_dword v209, v210, s[32:35], 0 offen
TNE:
Lend:
s_endpgm
RG0L:
s_mov_b32 s93, 0
RG0Ll:
buffer_load_dwordx4 v[176:179], v14, s[32:35], s8 offen sc1
buffer_load_dwordx4 v[180:183], v14, s[32:35], s9 offen sc1
buffer_load_dword v238, v222, s[32:35], s8 offen sc1
s_add_u32 s93, s93, 1
s_waitcnt vmcnt(0)
s_cmp_ge_u32 s93, 262144
s_cbranch_scc1 RG0Lx
v_add3_u32 v223, v176, v177, v178
v_add3_u32 v215, v180, v181, v182
v_add3_u32 v223, v223, v179, s98
v_add3_u32 v223, v223, v215, v183
v_add_u32_dpp v215, v238, v238 row_ror:4 row_mask:0xf bank_mask:0xf
s_nop 0
v_add_u32_dpp v223, v223, v223 row_ror:4 row_mask:0xf bank_mask:0xf
s_nop 1
v_add_u32_dpp v223, v223, v223 row_ror:8 row_mask:0xf bank_mask:0xf
v_cmp_ne_u32 vcc, v223, v215
s_nop 0
s_cmp_lg_u64 vcc, 0
s_cbranch_scc1 RG0Ll
RG0Lx:
s_branch BG0L
RG0S:
s_mov_b32 s93, 0
RG0Sl:
buffer_load_dwordx4 v[176:179], v14, s[32:35], s8 offen sc1
buffer_load_dwordx4 v[180:183], v14, s[32:35], s9 offen sc1
buffer_load_dword v238, v222, s[32:35], s8 offen sc1
s_add_u32 s93, s93, 1
s_waitcnt vmcnt(0)
s_cmp_ge_u32 s93, 262144
s_cbranch_scc1 RG0Sx
v_add3_u32 v223, v176, v177, v178
v_add3_u32 v215, v180, v181, v182
v_add3_u32 v223, v223, v179, s98
v_add3_u32 v223, v223, v215, v183
v_add_u32_dpp v215, v238, v238 row_ror:4 row_mask:0xf bank_mask:0xf
s_nop 0
v_add_u32_dpp v223, v223, v223 row_ror:4 row_mask:0xf bank_mask:0xf
s_nop 1
v_add_u32_dpp v223, v223, v223 row_ror:8 row_mask:0xf bank_mask:0xf
v_cmp_ne_u32 vcc, v223, v215
s_nop 0
s_cmp_lg_u64 vcc, 0
s_cbranch_scc1 RG0Sl
RG0Sx:
s_branch BG0S
RG1:
s_mov_b32 s93, 0
RG1l:
buffer_load_dwordx4 v[184:187], v14, s[32:35], s10 offen sc1
buffer_load_dwordx4 v[188:191], v14, s[32:35], s11 offen sc1
buffer_load_dword v239, v222, s[32:35], s10 offen sc1
s_add_u32 s93, s93, 1
s_waitcnt vmcnt(0)
s_cmp_ge_u32 s93, 262144
s_cbranch_scc1 RG1x
v_add3_u32 v223, v184, v185, v186
v_add3_u32 v215, v188, v189, v190
v_add3_u32 v223, v223, v187, s98
v_add3_u32 v223, v223, v215, v191
v_add_u32_dpp v215, v239, v239 row_ror:4 row_mask:0xf bank_mask:0xf
s_nop 0
v_add_u32_dpp v223, v223, v223 row_ror:4 row_mask:0xf bank_mask:0xf
s_nop 1
v_add_u32_dpp v223, v223, v223 row_ror:8 row_mask:0xf bank_mask:0xf
v_cmp_ne_u32 vcc, v223, v215
s_nop 0
s_cmp_lg_u64 vcc, 0
s_cbranch_scc1 RG1l
RG1x:
s_branch BG1
RG2:
s_mov_b32 s93, 0
RG2l:
buffer_load_dwordx4 v[144:147], v214, s[76:79], s12 offen sc1
buffer_load_dwordx4 v[148:151], v214, s[76:79], s13 offen sc1
buffer_load_dword v240, v222, s[32:35], s44 offen sc1
s_add_u32 s93, s93, 1
s_waitcnt vmcnt(0)
s_cmp_ge_u32 s93, 262144
s_cbranch_scc1 RG2x
v_add3_u32 v223, v144, v145, v146
v_add3_u32 v215, v148, v149, v150
v_add3_u32 v223, v223, v147, s98
v_add3_u32 v223, v223, v215, v151
v_add_u32_dpp v215, v240, v240 row_ror:4 row_mask:0xf bank_mask:0xf
s_nop 0
v_add_u32_dpp v223, v223, v223 row_ror:4 row_mask:0xf bank_mask:0xf
s_nop 1
v_add_u32_dpp v223, v223, v223 row_ror:8 row_mask:0xf bank_mask:0xf
v_cmp_ne_u32 vcc, v223, v215
s_nop 0
s_cmp_lg_u64 vcc, 0
s_cbranch_scc1 RG2l
RG2x:
s_branch BG2
RKL:
s_mov_b32 s93, 0
RKLl:
v_lshlrev_b32 v216, 1, v247
buffer_load_dwordx2 v[216:217], v216, s[32:35], s73 offen sc1
s_add_u32 s93, s93, 1
s_waitcnt vmcnt(0)
s_cmp_ge_u32 s93, 262144
s_cbranch_scc1 RKLx
v_cmp_ne_u32 vcc, s89, v217
s_nop 0
s_cmp_lg_u64 vcc, 0
s_cbranch_scc1 RKLl
RKLx:
s_branch BKL
RKS:
s_mov_b32 s93, 0
RKSl:
v_lshlrev_b32 v216, 1, v247
buffer_load_dwordx2 v[216:217], v216, s[32:35], s73 offen sc1
s_add_u32 s93, s93, 1
s_waitcnt vmcnt(0)
s_cmp_ge_u32 s93, 262144
s_cbranch_scc1 RKSx
v_cmp_ne_u32 vcc, s89, v217
s_nop 0
s_cmp_lg_u64 vcc, 0
s_cbranch_scc1 RKSl
RKSx:
s_branch BKS
RSTL:
s_mov_b32 s93, 0
RSTLl:
buffer_load_dwordx4 v[234:237], v222, s[32:35], s75 offen sc1
buffer_load_dwordx4 v[208:211], v193, s[32:35], s36 offen sc1
s_add_u32 s93, s93, 1
s_waitcnt vmcnt(0)
s_cmp_ge_u32 s93, 262144
s_cbranch_scc1 RSTLx
v_cmp_ne_u32 vcc, s89, v237
v_cmp_ne_u32 s[40:41], s89, v211
s_nop 0
s_or_b32 s40, s40, vcc_lo
s_cbranch_scc1 RSTLl
RSTLx:
s_branch BSTL
RSTS:
s_mov_b32 s93, 0
RSTSl:
buffer_load_dwordx4 v[234:237], v222, s[32:35], s75 offen sc1
buffer_load_dwordx4 v[208:211], v193, s[32:35], s36 offen sc1
s_add_u32 s93, s93, 1
s_waitcnt vmcnt(0)
s_cmp_ge_u32 s93, 262144
s_cbranch_scc1 RSTSx
v_cmp_ne_u32 vcc, s89, v237
v_cmp_ne_u32 s[40:41], s89, v211
s_nop 0
s_or_b32 s40, s40, vcc_lo
s_cbranch_scc1 RSTSl
RSTSx:
s_branch BSTS
RCS0L:
s_mov_b32 s93, 0
RCS0Ll:
buffer_load_dwordx4 v[212:215], v194, s[32:35], s74 offen offset:0 sc1
s_add_u32 s93, s93, 1
s_waitcnt vmcnt(0)
s_cmp_ge_u32 s93, 262144
s_cbranch_scc1 RCS0Lx
v_cmp_ne_u32 vcc, s89, v215
s_nop 0
s_cmp_lg_u64 vcc, 0
s_cbranch_scc1 RCS0Ll
RCS0Lx:
s_branch BCS0L
RCS0S:
s_mov_b32 s93, 0
RCS0Sl:
buffer_load_dwordx4 v[212:215], v194, s[32:35], s74 offen offset:0 sc1
s_add_u32 s93, s93, 1
s_waitcnt vmcnt(0)
s_cmp_ge_u32 s93, 262144
s_cbranch_scc1 RCS0Sx
v_cmp_ne_u32 vcc, s89, v215
s_nop 0
s_cmp_lg_u64 vcc, 0
s_cbranch_scc1 RCS0Sl
RCS0Sx:
s_branch BCS0S
RCS1L:
s_mov_b32 s93, 0
RCS1Ll:
buffer_load_dwordx4 v[212:215], v194, s[32:35], s74 offen offset:2048 sc1
s_add_u32 s93, s93, 1
s_waitcnt vmcnt(0)
s_cmp_ge_u32 s93, 262144
s_cbranch_scc1 RCS1Lx
v_cmp_ne_u32 vcc, s89, v215
s_nop 0
s_cmp_lg_u64 vcc, 0
s_cbranch_scc1 RCS1Ll
RCS1Lx:
s_branch BCS1L
RCS1S:
s_mov_b32 s93, 0
RCS1Sl:
buffer_load_dwordx4 v[212:215], v194, s[32:35], s74 offen offset:2048 sc1
s_add_u32 s93, s93, 1
s_waitcnt vmcnt(0)
s_cmp_ge_u32 s93, 262144
s_cbranch_scc1 RCS1Sx
v_cmp_ne_u32 vcc, s89, v215
s_nop 0
s_cmp_lg_u64 vcc, 0
s_cbranch_scc1 RCS1Sl
RCS1Sx:
s_branch BCS1S
RXCL:
s_mov_b32 s93, 0
RXCLl:
v_min_u32 v199, 6, v0
v_lshlrev_b32 v199, 8, v199
s_lshl_b32 s41, s87, 11
s_add_u32 s41, s41, 655360
buffer_load_dword v198, v199, s[32:35], s41 offen sc1
s_add_u32 s93, s93, 1
s_waitcnt vmcnt(0)
s_cmp_ge_u32 s93, 262144
s_cbranch_scc1 RXCLx
v_xor_b32 v199, s89, v198
v_cmp_lt_u32 vcc, 15, v199
s_nop 0
s_cmp_lg_u64 vcc, 0
s_cbranch_scc1 RXCLl
RXCLx:
s_branch BXCL
RXCS:
s_mov_b32 s93, 0
RXCSl:
v_min_u32 v199, 6, v0
v_lshlrev_b32 v199, 8, v199
s_lshl_b32 s41, s87, 11
s_add_u32 s41, s41, 655360
buffer_load_dword v198, v199, s[32:35], s41 offen sc1
s_add_u32 s93, s93, 1
s_waitcnt vmcnt(0)
s_cmp_ge_u32 s93, 262144
s_cbranch_scc1 RXCSx
v_xor_b32 v199, s89, v198
v_cmp_lt_u32 vcc, 15, v199
s_nop 0
s_cmp_lg_u64 vcc, 0
s_cbranch_scc1 RXCSl
RXCSx:
s_branch BXCS
SA1:
buffer_store_dwordx4 v[112:115], v214, s[76:79], s61 offen sc1
s_branch SB1
SA2:
buffer_store_dwordx4 v[116:119], v214, s[76:79], s71 offen sc1
s_branch SB2
SA3:
buffer_store_dword v212, v208, s[32:35], s99 offen sc1
s_branch SB3
SA4:
buffer_store_dwordx4 v[112:115], v214, s[76:79], s61 offen sc1
s_branch SB4
SA5:
buffer_store_dwordx4 v[116:119], v214, s[76:79], s71 offen sc1
s_branch SB5
SA6:
buffer_store_dword v212, v208, s[32:35], s99 offen sc1
s_branch SB6
.p2align 12
HELP0:
HELPW:
s_mov_b32 s86, s92
s_add_u32 s88, s94, s91
s_xor_b32 s70, s91, 4
s_cmp_eq_u32 s94, 3
s_cselect_b32 s88, 3, s88
s_cselect_b32 s95, s91, 0
s_cselect_b32 s70, s70, 0
v_lshrrev_b32 v140, 3, v0
v_and_b32 v141, 7, v0
v_lshl_add_u32 v140, s85, 3, v140
v_lshlrev_b32 v146, 4, v141
s_movk_i32 s94, 3584
v_mad_u32_u24 v140, v140, s94, v146
s_lshl_b32 s90, s88, 2
s_add_u32 s90, s90, s92
s_lshl_b32 s3, s90, 7
s_lshl_b32 s92, s90, 10
s_add_u32 s92, s92, 32768
s_cmp_lg_u32 s95, 0
s_cselect_b32 s3, 0x40000000, s3
s_cselect_b32 s92, 0x40000000, s92
v_lshl_add_u32 v151, s90, 6, v0
v_lshlrev_b32 v151, 1, v151
s_mov_b32 s96, 0
s_mov_b32 s97, -1
v_and_b32 v180, 7, v0
v_bfe_u32 v181, v0, 4, 1
v_lshl_add_u32 v180, v181, 3, v180
v_lshl_add_u32 v180, s86, 4, v180
v_lshl_add_u32 v180, s88, 6, v180
v_lshlrev_b32 v180, 1, v180
s_mov_b32 s18, 1605632
s_mov_b32 s19, 0x20000
s_mov_b32 s34, 268435456
s_mov_b32 s35, 0x20000
s_waitcnt lgkmcnt(0)
s_load_dword s89, s[32:33], 0
global_load_ushort v178, v180, s[40:41]
global_load_ushort v176, v180, s[36:37]
global_load_ushort v177, v180, s[38:39]
global_load_ushort v151, v151, s[44:45]
buffer_load_dwordx4 v[16:19], v140, s[16:19], s3 offen
s_add_u32 s3, s3, 114688
buffer_load_dwordx4 v[20:23], v140, s[16:19], s3 offen
s_add_u32 s3, s3, 114688
buffer_load_dwordx4 v[24:27], v140, s[16:19], s3 offen
s_add_u32 s3, s3, 114688
buffer_load_dwordx4 v[28:31], v140, s[16:19], s3 offen
s_add_u32 s3, s3, 114688
buffer_load_dwordx4 v[32:35], v140, s[16:19], s3 offen
s_add_u32 s3, s3, 114688
buffer_load_dwordx4 v[36:39], v140, s[16:19], s3 offen
s_add_u32 s3, s3, 114688
buffer_load_dwordx4 v[40:43], v140, s[16:19], s3 offen
s_add_u32 s3, s3, 114688
buffer_load_dwordx4 v[44:47], v140, s[16:19], s3 offen
s_add_u32 s3, s3, 114688
buffer_load_dwordx4 v[48:51], v140, s[16:19], s3 offen
s_add_u32 s3, s3, 114688
buffer_load_dwordx4 v[52:55], v140, s[16:19], s3 offen
s_add_u32 s3, s3, 114688
buffer_load_dwordx4 v[56:59], v140, s[16:19], s3 offen
s_add_u32 s3, s3, 114688
buffer_load_dwordx4 v[60:63], v140, s[16:19], s3 offen
s_add_u32 s3, s3, 114688
buffer_load_dwordx4 v[64:67], v140, s[16:19], s3 offen
s_add_u32 s3, s3, 114688
buffer_load_dwordx4 v[68:71], v140, s[16:19], s3 offen
v_and_b32 v142, 1, v0
v_lshlrev_b32 v142, 4, v142
v_bfe_u32 v143, v0, 1, 3
v_mov_b32 v144, 0x3f80
v_lshlrev_b32 v142, v142, v144
v_cmp_eq_u32 vcc, 0, v143
s_nop 1
v_cndmask_b32 v128, 0, v142, vcc
v_cmp_eq_u32 vcc, 1, v143
s_nop 1
v_cndmask_b32 v129, 0, v142, vcc
v_cmp_eq_u32 vcc, 2, v143
s_nop 1
v_cndmask_b32 v130, 0, v142, vcc
v_cmp_eq_u32 vcc, 3, v143
s_nop 1
v_cndmask_b32 v131, 0, v142, vcc
v_bfe_u32 v143, v0, 4, 1
v_lshrrev_b32 v144, 5, v0
v_lshlrev_b32 v141, 5, v141
v_lshl_add_u32 v141, v143, 4, v141
v_lshl_add_u32 v141, v144, 10, v141
v_lshl_add_u32 v141, s85, 8, v141
v_lshlrev_b32 v145, 2, v0
v_lshlrev_b32 v146, 4, v0
s_waitcnt vmcnt(13)
v_mfma_f32_16x16x32_bf16 v[132:135], v[128:131], v[16:19], 0
s_waitcnt vmcnt(12)
v_mfma_f32_16x16x32_bf16 v[132:135], v[128:131], v[20:23], v[132:135]
s_waitcnt vmcnt(11)
v_mfma_f32_16x16x32_bf16 v[132:135], v[128:131], v[24:27], v[132:135]
s_waitcnt vmcnt(10)
v_mfma_f32_16x16x32_bf16 v[132:135], v[128:131], v[28:31], v[132:135]
s_waitcnt vmcnt(9)
v_mfma_f32_16x16x32_bf16 v[132:135], v[128:131], v[32:35], v[132:135]
s_waitcnt vmcnt(8)
v_mfma_f32_16x16x32_bf16 v[132:135], v[128:131], v[36:39], v[132:135]
s_waitcnt vmcnt(7)
v_mfma_f32_16x16x32_bf16 v[132:135], v[128:131], v[40:43], v[132:135]
s_waitcnt vmcnt(6)
v_mfma_f32_16x16x32_bf16 v[132:135], v[128:131], v[44:47], v[132:135]
s_waitcnt vmcnt(5)
v_mfma_f32_16x16x32_bf16 v[132:135], v[128:131], v[48:51], v[132:135]
s_waitcnt vmcnt(4)
v_mfma_f32_16x16x32_bf16 v[132:135], v[128:131], v[52:55], v[132:135]
s_waitcnt vmcnt(3)
v_mfma_f32_16x16x32_bf16 v[132:135], v[128:131], v[56:59], v[132:135]
s_waitcnt vmcnt(2)
v_mfma_f32_16x16x32_bf16 v[132:135], v[128:131], v[60:63], v[132:135]
s_waitcnt vmcnt(1)
v_mfma_f32_16x16x32_bf16 v[132:135], v[128:131], v[64:67], v[132:135]
s_waitcnt vmcnt(0)
v_mfma_f32_16x16x32_bf16 v[132:135], v[128:131], v[68:71], v[132:135]
s_nop 7
v_add_f32_dpp v136, v132, v132 row_ror:8 row_mask:0xf bank_mask:0xf
v_add_f32_dpp v137, v133, v133 row_ror:8 row_mask:0xf bank_mask:0xf
v_add_f32_dpp v138, v134, v134 row_ror:8 row_mask:0xf bank_mask:0xf
v_add_f32_dpp v139, v135, v135 row_ror:8 row_mask:0xf bank_mask:0xf
ds_write_b128 v141, v[136:139]
s_waitcnt lgkmcnt(0)
s_or_b32 s89, s89, 1
s_add_u32 s89, s89, 1013904242
s_barrier
s_cmp_lg_u32 s84, 4
s_cbranch_scc1 HC
ds_read_b32 v72, v145 offset:0
ds_read_b32 v73, v145 offset:256
ds_read_b32 v74, v145 offset:512
ds_read_b32 v75, v145 offset:768
s_waitcnt lgkmcnt(2)
v_add_f32 v72, v72, v73
s_waitcnt lgkmcnt(0)
v_add_f32 v74, v74, v75
v_add_f32 v72, v72, v74
v_cvt_pk_bf16_f32 v74, v72, v72
v_lshl_or_b32 v73, v151, 16, v151
v_and_b32 v74, 0xffff0000, v74
v_mov_b32 v75, s89
v_sub_f32 v72, v72, v74
v_cvt_pk_bf16_f32 v72, v74, v72
v_mov_b32 v74, v72
buffer_store_dwordx4 v[72:75], v146, s[32:35], s92 offen sc1
HC:
s_cmp_eq_u32 s84, 7
s_cbranch_scc1 HSC
s_lshr_b32 s94, s2, 3
s_mul_i32 s94, s94, 3
s_add_u32 s94, s94, s85
s_mul_i32 s94, s94, 3072
s_getpc_b64 s[64:65]
PCL:
s_sub_u32 s64, s64, PCL-ROLEL
s_subb_u32 s65, s65, 0
v_lshl_add_u32 v148, v0, 4, s94
v_mov_b32 v149, 0
v_min_u32 v148, HELP0-ROLEL-2064, v148
v_lshl_add_u64 v[148:149], v[148:149], 0, s[64:65]
global_load_dwordx4 v[200:203], v[148:149], off offset:0
global_load_dwordx4 v[200:203], v[148:149], off offset:1024
global_load_dwordx4 v[200:203], v[148:149], off offset:2048
s_cmp_ge_u32 s92, 0x40000000
s_cbranch_scc1 HT
s_mul_i32 s94, s90, 7
s_add_u32 s94, s94, s85
s_lshl_b32 s94, s94, 13
s_mul_i32 s95, s86, 112
s_mul_i32 s91, s85, 38
s_add_u32 s95, s95, s91
s_mul_i32 s95, s95, 896
s_lshl_b32 s91, s88, 7
s_add_u32 s95, s95, s91
s_mov_b32 s22, 1605632
s_mov_b32 s23, 0x20000
s_mov_b32 s26, 401408
s_mov_b32 s27, 0x20000
s_mov_b32 s30, 401408
s_mov_b32 s31, 0x20000
v_min_u32 v151, 37, v0
v_lshlrev_b32 v150, 7, v0
v_mul_u32_u24 v151, 896, v151
s_add_u32 s91, s94, 24576
s_add_u32 s92, s94, 49152
s_cmp_eq_u32 s85, 0
buffer_load_dword v204, v150, s[20:23], s94 offen
buffer_load_dword v205, v150, s[20:23], s91 offen
buffer_load_dword v206, v151, s[24:27], s95 offen
buffer_load_dword v207, v151, s[28:31], s95 offen
s_cbranch_scc0 HT
buffer_load_dword v204, v150, s[20:23], s92 offen
s_branch HT
HSC:
s_cmp_lg_u32 s70, 0
s_cbranch_scc1 HT
s_setprio 3
v_and_b32 v142, 31, v0
v_lshrrev_b32 v143, 5, v0
v_lshlrev_b32 v142, 4, v142
v_lshl_add_u32 v142, v143, 12, v142
s_lshl_b32 s91, s90, 13
s_add_u32 s92, s91, 393216
s_add_u32 s91, s91, 131072
v_and_b32 v146, 31, v0
v_lshlrev_b32 v146, 3, v146
v_lshl_add_u32 v146, v143, 12, v146
v_bfe_u32 v179, v0, 3, 1
v_lshlrev_b32 v178, 16, v178
v_lshlrev_b32 v176, 16, v176
v_lshlrev_b32 v177, 16, v177
v_mul_f32 v178, 0x3fb8aa3b, v178
v_lshlrev_b32 v179, 31, v179
v_exp_f32 v178, v178
v_mul_f32 v182, v176, v176
v_fmac_f32 v182, v177, v177
v_cvt_pk_bf16_f32 v178, v178, v178
v_rcp_f32 v182, v182
v_lshlrev_b32 v178, 16, v178
v_mul_f32 v180, v178, v176
v_mul_f32 v181, v178, v177
v_mul_f32 v180, 0x3fb8aa3b, v180
v_mul_f32 v181, 0.15915494309189532, v181
v_exp_f32 v180, v180
v_fract_f32 v181, v181
v_cos_f32 v183, v181
v_sin_f32 v184, v181
v_add_f32 v182, v182, v182
v_mul_f32 v9, v183, v180
v_mul_f32 v184, v184, v180
v_add_f32 v183, -1.0, v9
v_xor_b32 v10, v179, v184
v_mul_f32 v185, v183, v176
v_mul_f32 v186, v183, v177
v_fmac_f32 v185, v184, v177
v_fma_f32 v186, -v184, v176, v186
v_mul_f32 v185, v185, v182
v_mul_f32 v227, v186, v182
v_xor_b32 v226, v179, v185
v_mul_f32 v187, v10, v10
v_add_f32 v188, v9, v9
v_fma_f32 v180, v9, v9, -v187
v_mul_f32 v181, v188, v10
v_mul_f32 v187, v181, v181
v_add_f32 v188, v180, v180
v_fma_f32 v182, v180, v180, -v187
v_mul_f32 v183, v188, v181
v_mul_f32 v187, v183, v183
v_add_f32 v188, v182, v182
v_fma_f32 v11, v182, v182, -v187
v_mul_f32 v12, v188, v183
v_mul_f32 v187, v12, v12
v_add_f32 v188, v11, v11
v_fma_f32 v13, v11, v11, -v187
v_mul_f32 v14, v188, v12
v_mul_f32 v187, v14, v14
v_add_f32 v188, v13, v13
v_fma_f32 v228, v13, v13, -v187
v_mul_f32 v229, v188, v14
v_mul_f32 v187, v229, v229
v_add_f32 v188, v228, v228
v_fma_f32 v230, v228, v228, -v187
v_mul_f32 v231, v188, v229
v_mul_f32 v187, v231, v231
v_add_f32 v188, v230, v230
v_fma_f32 v232, v230, v230, -v187
v_mul_f32 v233, v188, v231
v_mul_f32 v187, v233, v231
v_mul_f32 v188, v232, v231
v_fma_f32 v234, v232, v230, -v187
v_fma_f32 v235, v233, v230, v188
v_mul_f32 v187, v233, v233
v_add_f32 v188, v232, v232
v_fma_f32 v236, v232, v232, -v187
v_mul_f32 v237, v188, v233
v_mul_f32 v187, v237, v237
v_add_f32 v188, v236, v236
v_fma_f32 v238, v236, v236, -v187
v_mul_f32 v239, v188, v237
v_mul_f32 v187, v239, v237
v_mul_f32 v188, v238, v237
v_fma_f32 v240, v238, v236, -v187
v_fma_f32 v241, v239, v236, v188
v_mov_b32 v49, s89
v_mov_b32 v51, s89
v_mov_b32 v53, s89
v_mov_b32 v55, s89
v_mov_b32 v57, s89
v_mov_b32 v59, s89
v_mov_b32 v61, s89
v_mov_b32 v63, s89
v_mov_b32 v65, s89
v_mov_b32 v67, s89
v_mov_b32 v69, s89
v_mov_b32 v71, s89
v_mov_b32 v73, s89
v_mov_b32 v75, s89
v_mov_b32 v77, s89
v_mov_b32 v79, s89
s_mov_b32 s93, 0
HPOLL:
buffer_load_dwordx2 v[16:17], v146, s[32:35], s91 offen offset:0 sc1
buffer_load_dwordx2 v[18:19], v146, s[32:35], s91 offen offset:256 sc1
buffer_load_dwordx2 v[20:21], v146, s[32:35], s91 offen offset:512 sc1
buffer_load_dwordx2 v[22:23], v146, s[32:35], s91 offen offset:768 sc1
buffer_load_dwordx2 v[24:25], v146, s[32:35], s91 offen offset:1024 sc1
buffer_load_dwordx2 v[26:27], v146, s[32:35], s91 offen offset:1280 sc1
buffer_load_dwordx2 v[28:29], v146, s[32:35], s91 offen offset:1536 sc1
buffer_load_dwordx2 v[30:31], v146, s[32:35], s91 offen offset:1792 sc1
buffer_load_dwordx2 v[32:33], v146, s[32:35], s91 offen offset:2048 sc1
buffer_load_dwordx2 v[34:35], v146, s[32:35], s91 offen offset:2304 sc1
buffer_load_dwordx2 v[36:37], v146, s[32:35], s91 offen offset:2560 sc1
buffer_load_dwordx2 v[38:39], v146, s[32:35], s91 offen offset:2816 sc1
buffer_load_dwordx2 v[40:41], v146, s[32:35], s91 offen offset:3072 sc1
buffer_load_dwordx2 v[42:43], v146, s[32:35], s91 offen offset:3328 sc1
buffer_load_dwordx2 v[44:45], v146, s[32:35], s91 offen offset:3584 sc1
buffer_load_dwordx2 v[46:47], v146, s[32:35], s91 offen offset:3840 sc1
s_add_u32 s93, s93, 1
s_waitcnt vmcnt(14)
v_max_u32 v144, v17, v19
v_min_u32 v145, v17, v19
s_waitcnt vmcnt(12)
v_max3_u32 v144, v144, v21, v23
v_min3_u32 v145, v145, v21, v23
s_waitcnt vmcnt(10)
v_max3_u32 v144, v144, v25, v27
v_min3_u32 v145, v145, v25, v27
s_waitcnt vmcnt(8)
v_max3_u32 v144, v144, v29, v31
v_min3_u32 v145, v145, v29, v31
s_waitcnt vmcnt(6)
v_max3_u32 v144, v144, v33, v35
v_min3_u32 v145, v145, v33, v35
s_waitcnt vmcnt(4)
v_max3_u32 v144, v144, v37, v39
v_min3_u32 v145, v145, v37, v39
s_waitcnt vmcnt(2)
v_max3_u32 v144, v144, v41, v43
v_min3_u32 v145, v145, v41, v43
s_waitcnt vmcnt(0)
v_max3_u32 v144, v144, v45, v47
v_min3_u32 v145, v145, v45, v47
v_cmp_ne_u32 vcc, s89, v144
v_cmp_ne_u32 s[40:41], s89, v145
s_cmp_ge_u32 s93, 262144
s_cbranch_scc1 HGO
s_or_b64 vcc, vcc, s[40:41]
s_cbranch_scc1 HPOLL
HGO:
v_fma_f32 v19, v230, v16, v18
v_fma_f32 v27, v230, v24, v26
v_fma_f32 v35, v230, v32, v34
v_fma_f32 v43, v230, v40, v42
v_fmac_f32_dpp v19, v16, v231 row_ror:8 row_mask:0xf bank_mask:0xf
v_fmac_f32_dpp v27, v24, v231 row_ror:8 row_mask:0xf bank_mask:0xf
v_fmac_f32_dpp v35, v32, v231 row_ror:8 row_mask:0xf bank_mask:0xf
v_fmac_f32_dpp v43, v40, v231 row_ror:8 row_mask:0xf bank_mask:0xf
v_fma_f32 v21, v230, v19, v20
v_fma_f32 v29, v230, v27, v28
v_fma_f32 v37, v230, v35, v36
v_fma_f32 v45, v230, v43, v44
v_fmac_f32_dpp v21, v19, v231 row_ror:8 row_mask:0xf bank_mask:0xf
v_fmac_f32_dpp v29, v27, v231 row_ror:8 row_mask:0xf bank_mask:0xf
v_fmac_f32_dpp v37, v35, v231 row_ror:8 row_mask:0xf bank_mask:0xf
v_fmac_f32_dpp v45, v43, v231 row_ror:8 row_mask:0xf bank_mask:0xf
v_fma_f32 v23, v230, v21, v22
v_fma_f32 v31, v230, v29, v30
v_fma_f32 v39, v230, v37, v38
v_fma_f32 v47, v230, v45, v46
v_fmac_f32_dpp v23, v21, v231 row_ror:8 row_mask:0xf bank_mask:0xf
v_fmac_f32_dpp v31, v29, v231 row_ror:8 row_mask:0xf bank_mask:0xf
v_fmac_f32_dpp v39, v37, v231 row_ror:8 row_mask:0xf bank_mask:0xf
v_fmac_f32_dpp v47, v45, v231 row_ror:8 row_mask:0xf bank_mask:0xf
v_fma_f32 v25, v236, v23, v31
s_nop 1
v_fmac_f32_dpp v25, v23, v237 row_ror:8 row_mask:0xf bank_mask:0xf
v_fma_f32 v33, v236, v25, v39
s_nop 1
v_fmac_f32_dpp v33, v25, v237 row_ror:8 row_mask:0xf bank_mask:0xf
v_fma_f32 v41, v236, v33, v47
s_nop 1
v_fmac_f32_dpp v41, v33, v237 row_ror:8 row_mask:0xf bank_mask:0xf
v_mov_b32 v48, v41
v_mov_b32 v144, v41
s_nop 1
v_permlane32_swap_b32 v144, v48
v_cndmask_b32 v48, 0, v144, s[96:97]
v_fma_f32 v56, v236, v48, v23
v_fma_f32 v64, v238, v48, v25
v_fma_f32 v72, v240, v48, v33
v_fmac_f32_dpp v56, v48, v237 row_ror:8 row_mask:0xf bank_mask:0xf
v_fmac_f32_dpp v64, v48, v239 row_ror:8 row_mask:0xf bank_mask:0xf
v_fmac_f32_dpp v72, v48, v241 row_ror:8 row_mask:0xf bank_mask:0xf
v_fma_f32 v50, v230, v48, v16
v_fma_f32 v52, v232, v48, v19
v_fma_f32 v54, v234, v48, v21
v_fmac_f32_dpp v50, v48, v231 row_ror:8 row_mask:0xf bank_mask:0xf
v_fmac_f32_dpp v52, v48, v233 row_ror:8 row_mask:0xf bank_mask:0xf
v_fmac_f32_dpp v54, v48, v235 row_ror:8 row_mask:0xf bank_mask:0xf
buffer_store_dwordx4 v[48:51], v142, s[32:35], s92 offen offset:0 sc1
buffer_store_dwordx4 v[52:55], v142, s[32:35], s92 offen offset:512 sc1
v_fma_f32 v58, v230, v56, v24
v_fma_f32 v60, v232, v56, v27
v_fma_f32 v62, v234, v56, v29
v_fmac_f32_dpp v58, v56, v231 row_ror:8 row_mask:0xf bank_mask:0xf
v_fmac_f32_dpp v60, v56, v233 row_ror:8 row_mask:0xf bank_mask:0xf
v_fmac_f32_dpp v62, v56, v235 row_ror:8 row_mask:0xf bank_mask:0xf
buffer_store_dwordx4 v[56:59], v142, s[32:35], s92 offen offset:1024 sc1
buffer_store_dwordx4 v[60:63], v142, s[32:35], s92 offen offset:1536 sc1
v_fma_f32 v66, v230, v64, v32
v_fma_f32 v68, v232, v64, v35
v_fma_f32 v70, v234, v64, v37
v_fmac_f32_dpp v66, v64, v231 row_ror:8 row_mask:0xf bank_mask:0xf
v_fmac_f32_dpp v68, v64, v233 row_ror:8 row_mask:0xf bank_mask:0xf
v_fmac_f32_dpp v70, v64, v235 row_ror:8 row_mask:0xf bank_mask:0xf
buffer_store_dwordx4 v[64:67], v142, s[32:35], s92 offen offset:2048 sc1
buffer_store_dwordx4 v[68:71], v142, s[32:35], s92 offen offset:2560 sc1
v_fma_f32 v74, v230, v72, v40
v_fma_f32 v76, v232, v72, v43
v_fma_f32 v78, v234, v72, v45
v_fmac_f32_dpp v74, v72, v231 row_ror:8 row_mask:0xf bank_mask:0xf
v_fmac_f32_dpp v76, v72, v233 row_ror:8 row_mask:0xf bank_mask:0xf
v_fmac_f32_dpp v78, v72, v235 row_ror:8 row_mask:0xf bank_mask:0xf
buffer_store_dwordx4 v[72:75], v142, s[32:35], s92 offen offset:3072 sc1
buffer_store_dwordx4 v[76:79], v142, s[32:35], s92 offen offset:3584 sc1
HT:
s_barrier
s_lshr_b32 s94, s85, 1
s_lshl_b32 s94, s94, 2
s_and_b32 s91, s87, 4
s_andn2_b32 s92, s87, 4
s_add_u32 s92, s92, s94
s_cmp_eq_u32 s94, s91
s_cselect_b32 s94, 7, 5
s_sub_u32 s95, 13, s94
s_cmp_eq_u32 s91, 0
s_cselect_b32 s95, 0, s95
v_and_b32 v148, 7, v0
v_lshrrev_b32 v149, 3, v0
v_min_u32 v148, s94, v148
v_mul_u32_u24 v149, 1792, v149
v_add_u32 v148, s95, v148
s_lshl_b32 s91, s92, 1
s_and_b32 s94, s85, 1
s_add_u32 s91, s91, s94
s_mul_i32 s91, s91, 57344
v_lshl_add_u32 v148, v148, 7, v149
v_min_u32 v149, 13, v0
s_mul_i32 s92, s92, 365568
s_add_u32 s92, s92, 1091584
v_and_b32 v149, 15, v0
v_min_u32 v149, 13, v149
v_and_b32 v150, 14, v149
v_lshl_add_u32 v149, v150, 1, v149
v_mul_u32_u24 v149, 8704, v149
v_lshrrev_b32 v150, 4, v0
v_lshl_add_u32 v149, v150, 7, v149
s_mov_b32 s78, 3670016
s_mov_b32 s79, 0x20000
buffer_load_dword v150, v149, s[32:35], s92 offen
buffer_load_dword v151, v148, s[76:79], s91 offen
s_add_u32 s91, s91, 14336
buffer_load_dword v152, v148, s[76:79], s91 offen
s_add_u32 s91, s91, 14336
buffer_load_dword v153, v148, s[76:79], s91 offen
s_add_u32 s91, s91, 14336
buffer_load_dword v154, v148, s[76:79], s91 offen
HEND:
s_endpgm
HELPX:
s_load_dword s89, s[32:33], 0
s_mov_b32 s34, 268435456
s_mov_b32 s35, 0x20000
v_mov_b32 v128, 0x3f803f80
v_mov_b32 v129, 0x3f803f80
v_mov_b32 v130, 0x3f803f80
v_mov_b32 v131, 0x3f803f80
v_add_u32 v142, m0, v142
v_and_b32 v143, 1, v0
v_add_u32 v141, m0, v141
ds_write_b128 v142, v[128:131] offset:1024
v_lshl_add_u32 v141, v143, 10, v141
v_bfe_u32 v143, v0, 2, 2
v_lshrrev_b32 v144, 4, v0
v_lshlrev_b32 v147, 4, v140
v_xor_b32 v143, v143, v144
v_lshl_add_u32 v147, v143, 28, v147
s_mov_b32 s48, 0x22222222
s_mov_b32 s49, s48
s_lshl_b64 s[50:51], s[48:49], 1
s_lshl_b64 s[52:53], s[48:49], 2
s_waitcnt vmcnt(14)
ds_read_b128 v[72:75], v141 offset:0
ds_read_b128 v[76:79], v141 offset:64
ds_read_b128 v[80:83], v141 offset:128
ds_read_b128 v[84:87], v141 offset:192
ds_read_b128 v[88:91], v141 offset:256
ds_read_b128 v[92:95], v141 offset:320
ds_read_b128 v[96:99], v141 offset:384
ds_read_b128 v[100:103], v141 offset:448
ds_read_b128 v[104:107], v141 offset:512
ds_read_b128 v[108:111], v141 offset:576
ds_read_b128 v[112:115], v141 offset:640
ds_read_b128 v[116:119], v141 offset:704
ds_read_b128 v[120:123], v141 offset:768
ds_read_b128 v[124:127], v141 offset:832
s_waitcnt vmcnt(13)
v_mfma_f32_16x16x32_bf16 v[132:135], v[16:19], v[16:19], 0
s_waitcnt lgkmcnt(13)
v_mfma_f32_16x16x32_bf16 v[128:131], v[72:75], v[16:19], 0
s_waitcnt vmcnt(12)
v_mfma_f32_16x16x32_bf16 v[132:135], v[20:23], v[20:23], v[132:135]
s_waitcnt lgkmcnt(12)
v_mfma_f32_16x16x32_bf16 v[128:131], v[76:79], v[20:23], v[128:131]
s_waitcnt vmcnt(11)
v_mfma_f32_16x16x32_bf16 v[132:135], v[24:27], v[24:27], v[132:135]
s_waitcnt lgkmcnt(11)
v_mfma_f32_16x16x32_bf16 v[128:131], v[80:83], v[24:27], v[128:131]
s_waitcnt vmcnt(10)
v_mfma_f32_16x16x32_bf16 v[132:135], v[28:31], v[28:31], v[132:135]
s_waitcnt lgkmcnt(10)
v_mfma_f32_16x16x32_bf16 v[128:131], v[84:87], v[28:31], v[128:131]
s_waitcnt vmcnt(9)
v_mfma_f32_16x16x32_bf16 v[132:135], v[32:35], v[32:35], v[132:135]
s_waitcnt lgkmcnt(9)
v_mfma_f32_16x16x32_bf16 v[128:131], v[88:91], v[32:35], v[128:131]
s_waitcnt vmcnt(8)
v_mfma_f32_16x16x32_bf16 v[132:135], v[36:39], v[36:39], v[132:135]
s_waitcnt lgkmcnt(8)
v_mfma_f32_16x16x32_bf16 v[128:131], v[92:95], v[36:39], v[128:131]
s_waitcnt vmcnt(7)
v_mfma_f32_16x16x32_bf16 v[132:135], v[40:43], v[40:43], v[132:135]
s_waitcnt lgkmcnt(7)
v_mfma_f32_16x16x32_bf16 v[128:131], v[96:99], v[40:43], v[128:131]
s_waitcnt vmcnt(6)
v_mfma_f32_16x16x32_bf16 v[132:135], v[44:47], v[44:47], v[132:135]
s_waitcnt lgkmcnt(6)
v_mfma_f32_16x16x32_bf16 v[128:131], v[100:103], v[44:47], v[128:131]
s_waitcnt vmcnt(5)
v_mfma_f32_16x16x32_bf16 v[132:135], v[48:51], v[48:51], v[132:135]
s_waitcnt lgkmcnt(5)
v_mfma_f32_16x16x32_bf16 v[128:131], v[104:107], v[48:51], v[128:131]
s_waitcnt vmcnt(4)
v_mfma_f32_16x16x32_bf16 v[132:135], v[52:55], v[52:55], v[132:135]
s_waitcnt lgkmcnt(4)
v_mfma_f32_16x16x32_bf16 v[128:131], v[108:111], v[52:55], v[128:131]
s_waitcnt vmcnt(3)
v_mfma_f32_16x16x32_bf16 v[132:135], v[56:59], v[56:59], v[132:135]
s_waitcnt lgkmcnt(3)
v_mfma_f32_16x16x32_bf16 v[128:131], v[112:115], v[56:59], v[128:131]
s_waitcnt vmcnt(2)
v_mfma_f32_16x16x32_bf16 v[132:135], v[60:63], v[60:63], v[132:135]
s_waitcnt lgkmcnt(2)
v_mfma_f32_16x16x32_bf16 v[128:131], v[116:119], v[60:63], v[128:131]
s_waitcnt vmcnt(1)
v_mfma_f32_16x16x32_bf16 v[132:135], v[64:67], v[64:67], v[132:135]
s_waitcnt lgkmcnt(1)
v_mfma_f32_16x16x32_bf16 v[128:131], v[120:123], v[64:67], v[128:131]
s_waitcnt vmcnt(0)
v_mfma_f32_16x16x32_bf16 v[132:135], v[68:71], v[68:71], v[132:135]
s_waitcnt lgkmcnt(0)
v_mfma_f32_16x16x32_bf16 v[128:131], v[124:127], v[68:71], v[128:131]
s_waitcnt lgkmcnt(0)
s_or_b32 s89, s89, 1
s_add_u32 s89, s89, 1013904242
s_nop 2
v_cndmask_b32 v137, v132, v133, s[48:49]
v_cndmask_b32 v137, v137, v134, s[50:51]
v_cndmask_b32 v137, v137, v135, s[52:53]
v_mul_f32 v136, 0xbb124925, v129
v_mul_f32 v138, 0x3fb8aa3b, v128
v_mul_f32 v137, 0x3b124925, v137
v_exp_f32 v139, v138
v_fma_f32 v137, -v136, v136, v137
v_exp_f32 v138, -v138
v_max_f32 v137, 0, v137
v_cvt_pk_bf16_f32 v20, v136, v136
v_add_f32 v137, 0x3727c5ac, v137
v_add_f32 v138, 1.0, v138
v_rsq_f32 v24, v137
v_rcp_f32 v18, v138
v_and_b32 v25, 0xffff0000, v20
v_mov_b32 v19, s89
v_mul_f32 v137, v137, v24
v_mul_f32 v16, 0xc0135761, v24
v_sub_f32 v136, v136, v25
v_fma_f32 v17, v139, v137, v137
v_cvt_pk_bf16_f32 v25, v137, v137
v_min_f32 v17, 0x7149f2ca, v17
v_and_b32 v25, 0xffff0000, v25
s_lshl_b32 s91, s87, 10
s_add_u32 s91, s91, 65536
s_add_u32 s92, s91, 32768
buffer_store_dwordx4 v[16:19], v147, s[32:35], s91 offen sc1
v_cvt_pk_bf16_f32 v22, v136, v136
v_sub_f32 v137, v137, v25
v_mov_b32 v23, s89
v_cvt_pk_bf16_f32 v21, v25, v137
buffer_store_dwordx4 v[20:23], v147, s[32:35], s92 offen sc1
v_min_u32 v148, 6, v0
v_lshlrev_b32 v148, 7, v148
global_load_dword v151, v148, s[42:43]
global_load_dword v152, v148, s[46:47]
s_endpgm
CODE_END:
.section .rodata,"a"
.p2align 6
.amdhsa_kernel gated_mix__ssm_conv_s5__mixer_channel_mlp__prompt_kernel
  .amdhsa_next_free_vgpr 256
  .amdhsa_next_free_sgpr 102
  .amdhsa_accum_offset 256
  .amdhsa_group_segment_fixed_size 0
  .amdhsa_kernarg_size 144
  .amdhsa_user_sgpr_count 2
  .amdhsa_user_sgpr_kernarg_segment_ptr 1
  .amdhsa_system_sgpr_workgroup_id_x 1
.end_amdhsa_kernel
```
